```python
import torch

def _softmax(x, axis=-1):
    return torch.softmax(x, dim=axis)
def _gelu(x):
    return torch.nn.functional.gelu(x, approximate="tanh")
def _silu(x):
    return torch.nn.functional.silu(x)
def _sigmoid(x):
    return torch.sigmoid(x)
def _layernorm(x, axis=-1, eps=1e-5):
    m = x.mean(dim=axis, keepdim=True)
    v = x.var(dim=axis, keepdim=True, unbiased=False)
    return (x - m) / torch.sqrt(v + eps)
def _scatter_add(tgt, idx, src, axis=0):
    return tgt.clone().index_add_(axis, idx, src)
def _segment_sum(src, seg, n):
    out = torch.zeros((n,) + src.shape[1:], dtype=src.dtype)
    return out.index_add_(0, seg, src)
def _pad(x, pw):
    flat = tuple(v for pair in reversed(pw) for v in pair)
    return torch.nn.functional.pad(x, flat)

kernel_name = 'sequential_preLN__spectral_fnet__moe_arch_mod__prompt'

def setup_inputs():

    _w = (lambda a: (lambda t: t.to(torch.bfloat16) if t.is_floating_point() else t)(torch.as_tensor(a)))
    def _A_setup():
        B, S, D = 1, 2048, 512
        ns = torch.arange(S)[:, None] * torch.arange(S)[None, :]
        nd = torch.arange(D)[:, None] * torch.arange(D)[None, :]
        Ws_re = torch.cos(-2.0 * torch.pi * ns / S).to(float)
        Ws_im = torch.sin(-2.0 * torch.pi * ns / S).to(float)
        Wd_re = torch.cos(-2.0 * torch.pi * nd / D).to(float)
        Wd_im = torch.sin(-2.0 * torch.pi * nd / D).to(float)
        return {
            "x": _w((lambda *s: torch.randn(*s, dtype=torch.bfloat16) * 0.1)(B, S, D)),
            "dft_seq_re": _w(Ws_re),
            "dft_seq_im": _w(Ws_im),
            "dft_hid_re": _w(Wd_re),
            "dft_hid_im": _w(Wd_im),
        }
    _A_in = _A_setup()

    def _B_setup():
        B, S, D, F, C = 1, 2048, 512, 1792, 8
        return {
            "x": _w((lambda *s: torch.randn(*s, dtype=torch.bfloat16) * 0.1)(B, S, D)),
            "w_r": _w((lambda *s: torch.randn(*s, dtype=torch.bfloat16) * 1.6)(D)),
            "w_gate": _w((lambda *s: torch.randn(*s, dtype=torch.bfloat16) * 0.8)(D, F)),
            "w_up": _w((lambda *s: torch.randn(*s, dtype=torch.bfloat16) * 0.8)(D, F)),
            "w_down": _w((lambda *s: torch.randn(*s, dtype=torch.bfloat16) * 0.8)(F, D)),
        }
    _B_in = _B_setup()

    return {
        "A_x": _A_in["x"],
        "A_dft_seq_re": _A_in["dft_seq_re"],
        "A_dft_seq_im": _A_in["dft_seq_im"],
        "A_dft_hid_re": _A_in["dft_hid_re"],
        "A_dft_hid_im": _A_in["dft_hid_im"],
        "B_x": _B_in["x"],
        "B_w_r": _B_in["w_r"],
        "B_w_gate": _B_in["w_gate"],
        "B_w_up": _B_in["w_up"],
        "B_w_down": _B_in["w_down"],
    }

def reference(A_x, A_dft_seq_re, A_dft_seq_im, A_dft_hid_re, A_dft_hid_im, B_x, B_w_r, B_w_gate, B_w_up, B_w_down):
    def _A_ref(x, dft_seq_re, dft_seq_im, dft_hid_re, dft_hid_im):
        a = torch.einsum("bsd,ed->bse", x, dft_hid_re)
        b = torch.einsum("bsd,ed->bse", x, dft_hid_im)
        y = torch.einsum("ts,bse->bte", dft_seq_re, a) - torch.einsum("ts,bse->bte", dft_seq_im, b)
        return y

    def _B_ref(x, w_r, w_gate, w_up, w_down):
        B, S, D = x.shape
        C = 8
        r = x @ w_r
        idx = torch.argsort(-r, axis=-1)[:, :C]
        idx_e = (lambda x, n, axis: torch.repeat_interleave(x, n, dim=axis))(idx.reshape(B, C, 1), D, axis=2)
        x_sel = (lambda x, i, axis: torch.take_along_dim(x, i, dim=axis))(x, idx_e, axis=1)
        g = _silu(x_sel @ w_gate)
        u = x_sel @ w_up
        y = (g * u) @ w_down
        r_sel = _sigmoid((lambda x, i, axis: torch.take_along_dim(x, i, dim=axis))(r, idx, axis=1))
        y = y * r_sel.reshape(B, C, 1)
        b_off = (torch.arange(B) * S).reshape(B, 1)
        flat_idx = (idx + b_off).reshape(B * C)
        zero = (x * 0.0).reshape(B * S, D)
        upd = _scatter_add(zero, flat_idx, y.reshape(B * C, D), axis=0)
        return x + upd.reshape(B, S, D)

    x = A_x
    h = x + _A_ref(_layernorm(x, axis=-1), A_dft_seq_re, A_dft_seq_im, A_dft_hid_re, A_dft_hid_im)
    h2 = h + _B_ref(_layernorm(h, axis=-1), B_w_r, B_w_gate, B_w_up, B_w_down)
    return h2
```

```asm
; @launch kernel=k1_lngemm_kernel grid=(256,1,1) block=(512,1,1) lds=163840
; @launch kernel=k2_gemm_kernel grid=(256,1,1) block=(256,1,1) lds=147456
; @launch kernel=k3_tail_kernel grid=(256,1,1) block=(512,1,1) lds=61696
.amdgcn_target "amdgcn-amd-amdhsa--gfx950"
.text
.globl k1_lngemm_kernel
.p2align 8
.type k1_lngemm_kernel,@function
k1_lngemm_kernel:
    s_cmp_ge_u32 s2, 256
    s_cbranch_scc1 L_k1_end
    s_load_dwordx2 s[4:5], s[0:1], 0
    s_load_dwordx8 s[44:51], s[0:1], 8
    s_load_dwordx2 s[12:13], s[0:1], 96
    s_and_b32 s27, s2, 7
    s_lshr_b32 s26, s2, 3
    s_lshr_b32 s30, s26, 3
    s_lshl_b32 s28, s27, 2
    s_add_u32 s28, s28, s30
    s_and_b32 s29, s26, 7
    v_and_b32 v1, 63, v0
    v_lshrrev_b32 v2, 6, v0
    s_nop 0
    v_readfirstlane_b32 s30, v2
    s_and_b32 s32, s30, 1
    s_lshr_b32 s31, s30, 1
    v_and_b32 v8, 15, v1
    v_lshrrev_b32 v9, 4, v1
    v_lshlrev_b32 v10, 4, v1
    s_lshl_b32 s33, s28, 6
    s_lshl_b32 s34, s30, 3
    s_add_u32 s33, s33, s34
    v_add_u32 v2, s33, v9
    v_lshlrev_b32 v2, 10, v2
    v_lshl_add_u32 v2, v8, 4, v2
    s_lshl_b32 s33, s32, 7
    v_xor_b32 v4, s33, v10
    s_and_b32 s33, s29, 3
    s_lshl_b32 s33, s33, 7
    s_lshl_b32 s34, s30, 4
    s_add_u32 s33, s33, s34
    s_lshl_b32 s33, s33, 10
    s_lshl_b32 s34, s30, 14
    s_add_u32 s34, s34, 32768
    s_lshr_b32 s35, s27, 1
    s_lshl_b32 s35, s35, 21
    s_lshl_b32 s36, s26, 16
    s_add_u32 s35, s35, s36
    s_lshl_b32 s36, s30, 13
    s_add_u32 s35, s35, s36
    v_lshlrev_b32 v5, 7, v1
    v_add_u32 v5, s35, v5
    s_and_b32 s37, s29, 3
    s_lshl_b32 s37, s37, 1
    s_lshr_b32 s38, s30, 2
    s_add_u32 s37, s37, s38
    s_lshr_b32 s36, s29, 2
    s_lshl_b32 s35, s36, 21
    s_lshl_b32 s37, s37, 18
    s_add_u32 s35, s35, s37
    s_lshl_b32 s37, s28, 13
    s_add_u32 s35, s35, s37
    s_and_b32 s37, s31, 1
    s_lshl_b32 s37, s37, 12
    s_add_u32 s35, s35, s37
    s_lshl_b32 s37, s32, 10
    s_add_u32 s35, s35, s37
    v_add_u32 v3, s35, v10
    s_waitcnt lgkmcnt(0)
    s_mov_b32 s16, s4
    s_and_b32 s17, s5, 0xffff
    s_mov_b32 s18, 0x200000
    s_mov_b32 s19, 0x00020000
    s_cmp_eq_u32 s36, 0
    s_cselect_b32 s20, s48, s50
    s_cselect_b32 s21, s49, s51
    s_and_b32 s21, s21, 0xffff
    s_mov_b32 s22, 0x80000
    s_mov_b32 s23, 0x00020000
    s_and_b32 s37, s27, 1
    s_cmp_eq_u32 s37, 0
    s_cselect_b32 s52, s44, s46
    s_cselect_b32 s53, s45, s47
    s_and_b32 s53, s53, 0xffff
    s_mov_b32 s54, 0x800000
    s_mov_b32 s55, 0x00020000
    s_add_u32 s56, s12, 0x0
    s_addc_u32 s57, s13, 0
    s_and_b32 s57, s57, 0xffff
    s_mov_b32 s58, 0x400000
    s_mov_b32 s59, 0x00020000
    s_mov_b32 s38, 0
    buffer_load_dwordx4 v[64:67], v2, s[16:19], s38 offen offset:0
    buffer_load_dwordx4 v[68:71], v2, s[16:19], s38 offen offset:256
    buffer_load_dwordx4 v[72:75], v2, s[16:19], s38 offen offset:512
    buffer_load_dwordx4 v[76:79], v2, s[16:19], s38 offen offset:768
    s_mov_b32 s38, 4096
    buffer_load_dwordx4 v[80:83], v2, s[16:19], s38 offen offset:0
    buffer_load_dwordx4 v[84:87], v2, s[16:19], s38 offen offset:256
    buffer_load_dwordx4 v[88:91], v2, s[16:19], s38 offen offset:512
    buffer_load_dwordx4 v[92:95], v2, s[16:19], s38 offen offset:768
    s_add_u32 s43, s34, 0
    s_mov_b32 m0, s43
    s_add_u32 s41, s33, 0
    v_xor_b32 v7, 0x0, v4
    buffer_load_dwordx4 v7, s[20:23], s41 offen offset:0 lds
    v_xor_b32 v7, 0x10, v4
    buffer_load_dwordx4 v7, s[20:23], s41 offen offset:1024 lds
    v_xor_b32 v7, 0x20, v4
    buffer_load_dwordx4 v7, s[20:23], s41 offen offset:2048 lds
    v_xor_b32 v7, 0x30, v4
    buffer_load_dwordx4 v7, s[20:23], s41 offen offset:3072 lds
    s_and_b32 s40, s30, 3
    s_lshl_b32 s40, s40, 2
    v_add_u32 v14, s40, v9
    v_xor_b32 v14, v14, v8
    v_lshlrev_b32 v14, 4, v14
    s_lshl_b32 s40, s30, 3
    v_add_u32 v15, s40, v9
    v_lshl_add_u32 v16, v15, 9, v14
    v_add_u32 v17, 2048, v16
    v_lshrrev_b32 v14, 2, v8
    v_lshlrev_b32 v14, 3, v14
    v_and_b32 v15, 3, v8
    v_add_u32 v14, v14, v15
    s_lshl_b32 s40, s32, 5
    v_add_u32 v15, s40, v14
    v_lshlrev_b32 v15, 9, v15
    s_lshl_b32 s40, s31, 5
    v_add_u32 v14, s40, v14
    v_lshlrev_b32 v14, 10, v14
    v_add_u32 v14, 32768, v14
    v_add_u32 v18, 0, v9
    v_xor_b32 v18, v18, v8
    v_lshl_add_u32 v20, v18, 4, v15
    v_lshl_add_u32 v24, v18, 4, v14
    v_add_u32 v18, 4, v9
    v_xor_b32 v18, v18, v8
    v_lshl_add_u32 v21, v18, 4, v15
    v_lshl_add_u32 v25, v18, 4, v14
    v_add_u32 v18, 8, v9
    v_xor_b32 v18, v18, v8
    v_lshl_add_u32 v22, v18, 4, v15
    v_lshl_add_u32 v26, v18, 4, v14
    v_add_u32 v18, 12, v9
    v_xor_b32 v18, v18, v8
    v_lshl_add_u32 v23, v18, 4, v15
    v_lshl_add_u32 v27, v18, 4, v14
    v_mov_b32 v19, 0x3f803f80
    s_waitcnt vmcnt(4)
    v_mov_b32 v28, 0
    v_dot2_f32_bf16 v28, v64, v19, v28
    v_dot2_f32_bf16 v28, v65, v19, v28
    v_dot2_f32_bf16 v28, v66, v19, v28
    v_dot2_f32_bf16 v28, v67, v19, v28
    v_dot2_f32_bf16 v28, v68, v19, v28
    v_dot2_f32_bf16 v28, v69, v19, v28
    v_dot2_f32_bf16 v28, v70, v19, v28
    v_dot2_f32_bf16 v28, v71, v19, v28
    s_add_u32 s43, s34, 4096
    s_mov_b32 m0, s43
    s_add_u32 s41, s33, 4096
    v_xor_b32 v7, 0x0, v4
    buffer_load_dwordx4 v7, s[20:23], s41 offen offset:0 lds
    v_dot2_f32_bf16 v28, v72, v19, v28
    v_dot2_f32_bf16 v28, v73, v19, v28
    v_dot2_f32_bf16 v28, v74, v19, v28
    v_dot2_f32_bf16 v28, v75, v19, v28
    v_dot2_f32_bf16 v28, v76, v19, v28
    v_dot2_f32_bf16 v28, v77, v19, v28
    v_dot2_f32_bf16 v28, v78, v19, v28
    v_dot2_f32_bf16 v28, v79, v19, v28
    v_xor_b32 v7, 0x10, v4
    buffer_load_dwordx4 v7, s[20:23], s41 offen offset:1024 lds
    v_mov_b32 v29, 0
    v_dot2_f32_bf16 v29, v80, v19, v29
    v_dot2_f32_bf16 v29, v81, v19, v29
    v_dot2_f32_bf16 v29, v82, v19, v29
    v_dot2_f32_bf16 v29, v83, v19, v29
    v_dot2_f32_bf16 v29, v84, v19, v29
    v_dot2_f32_bf16 v29, v85, v19, v29
    v_dot2_f32_bf16 v29, v86, v19, v29
    v_dot2_f32_bf16 v29, v87, v19, v29
    v_xor_b32 v7, 0x20, v4
    buffer_load_dwordx4 v7, s[20:23], s41 offen offset:2048 lds
    v_dot2_f32_bf16 v29, v88, v19, v29
    v_dot2_f32_bf16 v29, v89, v19, v29
    v_dot2_f32_bf16 v29, v90, v19, v29
    v_dot2_f32_bf16 v29, v91, v19, v29
    v_dot2_f32_bf16 v29, v92, v19, v29
    v_dot2_f32_bf16 v29, v93, v19, v29
    v_dot2_f32_bf16 v29, v94, v19, v29
    v_dot2_f32_bf16 v29, v95, v19, v29
    v_xor_b32 v7, 0x30, v4
    buffer_load_dwordx4 v7, s[20:23], s41 offen offset:3072 lds
    s_nop 1
    s_nop 1
    v_add_f32_dpp v28, v28, v28 quad_perm:[1,0,3,2] row_mask:0xf bank_mask:0xf
    s_nop 1
    v_add_f32_dpp v28, v28, v28 quad_perm:[2,3,0,1] row_mask:0xf bank_mask:0xf
    s_nop 1
    v_add_f32_dpp v28, v28, v28 row_half_mirror row_mask:0xf bank_mask:0xf
    s_nop 1
    v_add_f32_dpp v28, v28, v28 row_mirror row_mask:0xf bank_mask:0xf
    s_nop 1
    v_add_f32_dpp v29, v29, v29 quad_perm:[1,0,3,2] row_mask:0xf bank_mask:0xf
    s_nop 1
    v_add_f32_dpp v29, v29, v29 quad_perm:[2,3,0,1] row_mask:0xf bank_mask:0xf
    s_nop 1
    v_add_f32_dpp v29, v29, v29 row_half_mirror row_mask:0xf bank_mask:0xf
    s_nop 1
    v_add_f32_dpp v29, v29, v29 row_mirror row_mask:0xf bank_mask:0xf
    v_mul_f32 v28, 0x3b000000, v28
    v_mov_b32 v32, v28
    v_cvt_pk_bf16_f32 v32, v32, v32
    v_lshlrev_b32 v32, 16, v32
    v_sub_f32 v28, v28, v32
    v_mul_f32 v29, 0x3b000000, v29
    v_mov_b32 v33, v29
    v_cvt_pk_bf16_f32 v33, v33, v33
    v_lshlrev_b32 v33, 16, v33
    v_sub_f32 v29, v29, v33
    v_mov_b32 v104, 0
    v_mov_b32 v105, 0
    v_lshlrev_b32 v112, 16, v64
    v_and_b32 v113, 0xffff0000, v64
    v_sub_f32 v112, v112, v32
    v_sub_f32 v113, v113, v32
    v_fmac_f32 v104, v112, v112
    v_fmac_f32 v105, v113, v113
    v_cvt_pk_bf16_f32 v64, v112, v113
    v_lshlrev_b32 v114, 16, v65
    v_and_b32 v115, 0xffff0000, v65
    v_sub_f32 v114, v114, v32
    v_sub_f32 v115, v115, v32
    v_fmac_f32 v104, v114, v114
    v_fmac_f32 v105, v115, v115
    v_cvt_pk_bf16_f32 v65, v114, v115
    v_lshlrev_b32 v116, 16, v66
    v_and_b32 v117, 0xffff0000, v66
    v_sub_f32 v116, v116, v32
    v_sub_f32 v117, v117, v32
    v_fmac_f32 v104, v116, v116
    v_fmac_f32 v105, v117, v117
    v_cvt_pk_bf16_f32 v66, v116, v117
    s_add_u32 s43, s34, 8192
    s_mov_b32 m0, s43
    s_add_u32 s41, s33, 8192
    v_xor_b32 v7, 0x40, v4
    buffer_load_dwordx4 v7, s[20:23], s41 offen offset:0 lds
    v_lshlrev_b32 v118, 16, v67
    v_and_b32 v119, 0xffff0000, v67
    v_sub_f32 v118, v118, v32
    v_sub_f32 v119, v119, v32
    v_fmac_f32 v104, v118, v118
    v_fmac_f32 v105, v119, v119
    v_cvt_pk_bf16_f32 v67, v118, v119
    v_lshlrev_b32 v112, 16, v68
    v_and_b32 v113, 0xffff0000, v68
    v_sub_f32 v112, v112, v32
    v_sub_f32 v113, v113, v32
    v_fmac_f32 v104, v112, v112
    v_fmac_f32 v105, v113, v113
    v_cvt_pk_bf16_f32 v68, v112, v113
    v_lshlrev_b32 v114, 16, v69
    v_and_b32 v115, 0xffff0000, v69
    v_sub_f32 v114, v114, v32
    v_sub_f32 v115, v115, v32
    v_fmac_f32 v104, v114, v114
    v_fmac_f32 v105, v115, v115
    v_cvt_pk_bf16_f32 v69, v114, v115
    v_xor_b32 v7, 0x50, v4
    buffer_load_dwordx4 v7, s[20:23], s41 offen offset:1024 lds
    v_lshlrev_b32 v116, 16, v70
    v_and_b32 v117, 0xffff0000, v70
    v_sub_f32 v116, v116, v32
    v_sub_f32 v117, v117, v32
    v_fmac_f32 v104, v116, v116
    v_fmac_f32 v105, v117, v117
    v_cvt_pk_bf16_f32 v70, v116, v117
    v_lshlrev_b32 v118, 16, v71
    v_and_b32 v119, 0xffff0000, v71
    v_sub_f32 v118, v118, v32
    v_sub_f32 v119, v119, v32
    v_fmac_f32 v104, v118, v118
    v_fmac_f32 v105, v119, v119
    v_cvt_pk_bf16_f32 v71, v118, v119
    v_lshlrev_b32 v112, 16, v72
    v_and_b32 v113, 0xffff0000, v72
    v_sub_f32 v112, v112, v32
    v_sub_f32 v113, v113, v32
    v_fmac_f32 v104, v112, v112
    v_fmac_f32 v105, v113, v113
    v_cvt_pk_bf16_f32 v72, v112, v113
    v_xor_b32 v7, 0x60, v4
    buffer_load_dwordx4 v7, s[20:23], s41 offen offset:2048 lds
    v_lshlrev_b32 v114, 16, v73
    v_and_b32 v115, 0xffff0000, v73
    v_sub_f32 v114, v114, v32
    v_sub_f32 v115, v115, v32
    v_fmac_f32 v104, v114, v114
    v_fmac_f32 v105, v115, v115
    v_cvt_pk_bf16_f32 v73, v114, v115
    v_lshlrev_b32 v116, 16, v74
    v_and_b32 v117, 0xffff0000, v74
    v_sub_f32 v116, v116, v32
    v_sub_f32 v117, v117, v32
    v_fmac_f32 v104, v116, v116
    v_fmac_f32 v105, v117, v117
    v_cvt_pk_bf16_f32 v74, v116, v117
    v_lshlrev_b32 v118, 16, v75
    v_and_b32 v119, 0xffff0000, v75
    v_sub_f32 v118, v118, v32
    v_sub_f32 v119, v119, v32
    v_fmac_f32 v104, v118, v118
    v_fmac_f32 v105, v119, v119
    v_cvt_pk_bf16_f32 v75, v118, v119
    v_xor_b32 v7, 0x70, v4
    buffer_load_dwordx4 v7, s[20:23], s41 offen offset:3072 lds
    v_lshlrev_b32 v112, 16, v76
    v_and_b32 v113, 0xffff0000, v76
    v_sub_f32 v112, v112, v32
    v_sub_f32 v113, v113, v32
    v_fmac_f32 v104, v112, v112
    v_fmac_f32 v105, v113, v113
    v_cvt_pk_bf16_f32 v76, v112, v113
    v_lshlrev_b32 v114, 16, v77
    v_and_b32 v115, 0xffff0000, v77
    v_sub_f32 v114, v114, v32
    v_sub_f32 v115, v115, v32
    v_fmac_f32 v104, v114, v114
    v_fmac_f32 v105, v115, v115
    v_cvt_pk_bf16_f32 v77, v114, v115
    v_lshlrev_b32 v116, 16, v78
    v_and_b32 v117, 0xffff0000, v78
    v_sub_f32 v116, v116, v32
    v_sub_f32 v117, v117, v32
    v_fmac_f32 v104, v116, v116
    v_fmac_f32 v105, v117, v117
    v_cvt_pk_bf16_f32 v78, v116, v117
    s_add_u32 s43, s34, 12288
    s_mov_b32 m0, s43
    s_add_u32 s41, s33, 12288
    v_xor_b32 v7, 0x40, v4
    buffer_load_dwordx4 v7, s[20:23], s41 offen offset:0 lds
    v_lshlrev_b32 v118, 16, v79
    v_and_b32 v119, 0xffff0000, v79
    v_sub_f32 v118, v118, v32
    v_sub_f32 v119, v119, v32
    v_fmac_f32 v104, v118, v118
    v_fmac_f32 v105, v119, v119
    v_cvt_pk_bf16_f32 v79, v118, v119
    v_add_f32 v36, v104, v105
    v_mov_b32 v106, 0
    v_mov_b32 v107, 0
    v_lshlrev_b32 v112, 16, v80
    v_and_b32 v113, 0xffff0000, v80
    v_sub_f32 v112, v112, v33
    v_sub_f32 v113, v113, v33
    v_fmac_f32 v106, v112, v112
    v_fmac_f32 v107, v113, v113
    v_cvt_pk_bf16_f32 v80, v112, v113
    v_lshlrev_b32 v114, 16, v81
    v_and_b32 v115, 0xffff0000, v81
    v_sub_f32 v114, v114, v33
    v_sub_f32 v115, v115, v33
    v_fmac_f32 v106, v114, v114
    v_fmac_f32 v107, v115, v115
    v_cvt_pk_bf16_f32 v81, v114, v115
    v_lshlrev_b32 v116, 16, v82
    v_and_b32 v117, 0xffff0000, v82
    v_sub_f32 v116, v116, v33
    v_sub_f32 v117, v117, v33
    v_fmac_f32 v106, v116, v116
    v_fmac_f32 v107, v117, v117
    v_cvt_pk_bf16_f32 v82, v116, v117
    v_xor_b32 v7, 0x50, v4
    buffer_load_dwordx4 v7, s[20:23], s41 offen offset:1024 lds
    v_lshlrev_b32 v118, 16, v83
    v_and_b32 v119, 0xffff0000, v83
    v_sub_f32 v118, v118, v33
    v_sub_f32 v119, v119, v33
    v_fmac_f32 v106, v118, v118
    v_fmac_f32 v107, v119, v119
    v_cvt_pk_bf16_f32 v83, v118, v119
    v_lshlrev_b32 v112, 16, v84
    v_and_b32 v113, 0xffff0000, v84
    v_sub_f32 v112, v112, v33
    v_sub_f32 v113, v113, v33
    v_fmac_f32 v106, v112, v112
    v_fmac_f32 v107, v113, v113
    v_cvt_pk_bf16_f32 v84, v112, v113
    v_lshlrev_b32 v114, 16, v85
    v_and_b32 v115, 0xffff0000, v85
    v_sub_f32 v114, v114, v33
    v_sub_f32 v115, v115, v33
    v_fmac_f32 v106, v114, v114
    v_fmac_f32 v107, v115, v115
    v_cvt_pk_bf16_f32 v85, v114, v115
    v_xor_b32 v7, 0x60, v4
    buffer_load_dwordx4 v7, s[20:23], s41 offen offset:2048 lds
    v_lshlrev_b32 v116, 16, v86
    v_and_b32 v117, 0xffff0000, v86
    v_sub_f32 v116, v116, v33
    v_sub_f32 v117, v117, v33
    v_fmac_f32 v106, v116, v116
    v_fmac_f32 v107, v117, v117
    v_cvt_pk_bf16_f32 v86, v116, v117
    v_lshlrev_b32 v118, 16, v87
    v_and_b32 v119, 0xffff0000, v87
    v_sub_f32 v118, v118, v33
    v_sub_f32 v119, v119, v33
    v_fmac_f32 v106, v118, v118
    v_fmac_f32 v107, v119, v119
    v_cvt_pk_bf16_f32 v87, v118, v119
    v_lshlrev_b32 v112, 16, v88
    v_and_b32 v113, 0xffff0000, v88
    v_sub_f32 v112, v112, v33
    v_sub_f32 v113, v113, v33
    v_fmac_f32 v106, v112, v112
    v_fmac_f32 v107, v113, v113
    v_cvt_pk_bf16_f32 v88, v112, v113
    v_xor_b32 v7, 0x70, v4
    buffer_load_dwordx4 v7, s[20:23], s41 offen offset:3072 lds
    v_lshlrev_b32 v114, 16, v89
    v_and_b32 v115, 0xffff0000, v89
    v_sub_f32 v114, v114, v33
    v_sub_f32 v115, v115, v33
    v_fmac_f32 v106, v114, v114
    v_fmac_f32 v107, v115, v115
    v_cvt_pk_bf16_f32 v89, v114, v115
    v_lshlrev_b32 v116, 16, v90
    v_and_b32 v117, 0xffff0000, v90
    v_sub_f32 v116, v116, v33
    v_sub_f32 v117, v117, v33
    v_fmac_f32 v106, v116, v116
    v_fmac_f32 v107, v117, v117
    v_cvt_pk_bf16_f32 v90, v116, v117
    v_lshlrev_b32 v118, 16, v91
    v_and_b32 v119, 0xffff0000, v91
    v_sub_f32 v118, v118, v33
    v_sub_f32 v119, v119, v33
    v_fmac_f32 v106, v118, v118
    v_fmac_f32 v107, v119, v119
    v_cvt_pk_bf16_f32 v91, v118, v119
    v_lshlrev_b32 v112, 16, v92
    v_and_b32 v113, 0xffff0000, v92
    v_sub_f32 v112, v112, v33
    v_sub_f32 v113, v113, v33
    v_fmac_f32 v106, v112, v112
    v_fmac_f32 v107, v113, v113
    v_cvt_pk_bf16_f32 v92, v112, v113
    v_lshlrev_b32 v114, 16, v93
    v_and_b32 v115, 0xffff0000, v93
    v_sub_f32 v114, v114, v33
    v_sub_f32 v115, v115, v33
    v_fmac_f32 v106, v114, v114
    v_fmac_f32 v107, v115, v115
    v_cvt_pk_bf16_f32 v93, v114, v115
    v_lshlrev_b32 v116, 16, v94
    v_and_b32 v117, 0xffff0000, v94
    v_sub_f32 v116, v116, v33
    v_sub_f32 v117, v117, v33
    v_fmac_f32 v106, v116, v116
    v_fmac_f32 v107, v117, v117
    v_cvt_pk_bf16_f32 v94, v116, v117
    v_lshlrev_b32 v118, 16, v95
    v_and_b32 v119, 0xffff0000, v95
    v_sub_f32 v118, v118, v33
    v_sub_f32 v119, v119, v33
    v_fmac_f32 v106, v118, v118
    v_fmac_f32 v107, v119, v119
    v_cvt_pk_bf16_f32 v95, v118, v119
    v_add_f32 v37, v106, v107
    s_nop 1
    v_add_f32_dpp v36, v36, v36 quad_perm:[1,0,3,2] row_mask:0xf bank_mask:0xf
    s_nop 1
    v_add_f32_dpp v36, v36, v36 quad_perm:[2,3,0,1] row_mask:0xf bank_mask:0xf
    s_nop 1
    v_add_f32_dpp v36, v36, v36 row_half_mirror row_mask:0xf bank_mask:0xf
    s_nop 1
    v_add_f32_dpp v36, v36, v36 row_mirror row_mask:0xf bank_mask:0xf
    s_nop 1
    v_add_f32_dpp v37, v37, v37 quad_perm:[1,0,3,2] row_mask:0xf bank_mask:0xf
    s_nop 1
    v_add_f32_dpp v37, v37, v37 quad_perm:[2,3,0,1] row_mask:0xf bank_mask:0xf
    s_nop 1
    v_add_f32_dpp v37, v37, v37 row_half_mirror row_mask:0xf bank_mask:0xf
    s_nop 1
    v_add_f32_dpp v37, v37, v37 row_mirror row_mask:0xf bank_mask:0xf
    v_mul_f32 v36, 0x3b000000, v36
    v_fma_f32 v36, -v28, v28, v36
    v_max_f32 v36, 0, v36
    v_cvt_pk_bf16_f32 v36, v36, v36
    v_lshlrev_b32 v36, 16, v36
    v_add_f32 v36, 0x3727c5ac, v36
    v_cvt_pk_bf16_f32 v36, v36, v36
    v_lshlrev_b32 v36, 16, v36
    v_sqrt_f32 v36, v36
    s_nop 0
    v_cvt_pk_bf16_f32 v36, v36, v36
    v_lshlrev_b32 v36, 16, v36
    v_rcp_f32 v96, v36
    v_mul_f32 v37, 0x3b000000, v37
    v_fma_f32 v37, -v29, v29, v37
    v_max_f32 v37, 0, v37
    v_cvt_pk_bf16_f32 v37, v37, v37
    v_lshlrev_b32 v37, 16, v37
    v_add_f32 v37, 0x3727c5ac, v37
    v_cvt_pk_bf16_f32 v37, v37, v37
    v_lshlrev_b32 v37, 16, v37
    v_sqrt_f32 v37, v37
    s_nop 0
    v_cvt_pk_bf16_f32 v37, v37, v37
    v_lshlrev_b32 v37, 16, v37
    v_rcp_f32 v97, v37
    s_nop 0
    v_lshlrev_b32 v112, 16, v64
    v_and_b32 v113, 0xffff0000, v64
    v_mul_f32 v112, v112, v96
    v_mul_f32 v113, v113, v96
    v_cvt_pk_bf16_f32 v64, v112, v113
    v_lshlrev_b32 v114, 16, v65
    v_and_b32 v115, 0xffff0000, v65
    v_mul_f32 v114, v114, v96
    v_mul_f32 v115, v115, v96
    v_cvt_pk_bf16_f32 v65, v114, v115
    v_lshlrev_b32 v116, 16, v66
    v_and_b32 v117, 0xffff0000, v66
    v_mul_f32 v116, v116, v96
    v_mul_f32 v117, v117, v96
    v_cvt_pk_bf16_f32 v66, v116, v117
    v_lshlrev_b32 v118, 16, v67
    v_and_b32 v119, 0xffff0000, v67
    v_mul_f32 v118, v118, v96
    v_mul_f32 v119, v119, v96
    v_cvt_pk_bf16_f32 v67, v118, v119
    ds_write_b128 v16, v[64:67] offset:0
    v_lshlrev_b32 v112, 16, v68
    v_and_b32 v113, 0xffff0000, v68
    v_mul_f32 v112, v112, v96
    v_mul_f32 v113, v113, v96
    v_cvt_pk_bf16_f32 v68, v112, v113
    v_lshlrev_b32 v114, 16, v69
    v_and_b32 v115, 0xffff0000, v69
    v_mul_f32 v114, v114, v96
    v_mul_f32 v115, v115, v96
    v_cvt_pk_bf16_f32 v69, v114, v115
    v_lshlrev_b32 v116, 16, v70
    v_and_b32 v117, 0xffff0000, v70
    v_mul_f32 v116, v116, v96
    v_mul_f32 v117, v117, v96
    v_cvt_pk_bf16_f32 v70, v116, v117
    v_lshlrev_b32 v118, 16, v71
    v_and_b32 v119, 0xffff0000, v71
    v_mul_f32 v118, v118, v96
    v_mul_f32 v119, v119, v96
    v_cvt_pk_bf16_f32 v71, v118, v119
    ds_write_b128 v16, v[68:71] offset:256
    v_lshlrev_b32 v112, 16, v72
    v_and_b32 v113, 0xffff0000, v72
    v_mul_f32 v112, v112, v96
    v_mul_f32 v113, v113, v96
    v_cvt_pk_bf16_f32 v72, v112, v113
    v_lshlrev_b32 v114, 16, v73
    v_and_b32 v115, 0xffff0000, v73
    v_mul_f32 v114, v114, v96
    v_mul_f32 v115, v115, v96
    v_cvt_pk_bf16_f32 v73, v114, v115
    v_lshlrev_b32 v116, 16, v74
    v_and_b32 v117, 0xffff0000, v74
    v_mul_f32 v116, v116, v96
    v_mul_f32 v117, v117, v96
    v_cvt_pk_bf16_f32 v74, v116, v117
    v_lshlrev_b32 v118, 16, v75
    v_and_b32 v119, 0xffff0000, v75
    v_mul_f32 v118, v118, v96
    v_mul_f32 v119, v119, v96
    v_cvt_pk_bf16_f32 v75, v118, v119
    v_lshlrev_b32 v112, 16, v76
    v_and_b32 v113, 0xffff0000, v76
    v_mul_f32 v112, v112, v96
    v_mul_f32 v113, v113, v96
    v_cvt_pk_bf16_f32 v76, v112, v113
    v_lshlrev_b32 v114, 16, v77
    v_and_b32 v115, 0xffff0000, v77
    v_mul_f32 v114, v114, v96
    v_mul_f32 v115, v115, v96
    v_cvt_pk_bf16_f32 v77, v114, v115
    v_lshlrev_b32 v116, 16, v78
    v_and_b32 v117, 0xffff0000, v78
    v_mul_f32 v116, v116, v96
    v_mul_f32 v117, v117, v96
    v_cvt_pk_bf16_f32 v78, v116, v117
    v_lshlrev_b32 v118, 16, v79
    v_and_b32 v119, 0xffff0000, v79
    v_mul_f32 v118, v118, v96
    v_mul_f32 v119, v119, v96
    v_cvt_pk_bf16_f32 v79, v118, v119
    v_lshlrev_b32 v112, 16, v80
    v_and_b32 v113, 0xffff0000, v80
    v_mul_f32 v112, v112, v97
    v_mul_f32 v113, v113, v97
    v_cvt_pk_bf16_f32 v80, v112, v113
    v_lshlrev_b32 v114, 16, v81
    v_and_b32 v115, 0xffff0000, v81
    v_mul_f32 v114, v114, v97
    v_mul_f32 v115, v115, v97
    v_cvt_pk_bf16_f32 v81, v114, v115
    v_lshlrev_b32 v116, 16, v82
    v_and_b32 v117, 0xffff0000, v82
    v_mul_f32 v116, v116, v97
    v_mul_f32 v117, v117, v97
    v_cvt_pk_bf16_f32 v82, v116, v117
    v_lshlrev_b32 v118, 16, v83
    v_and_b32 v119, 0xffff0000, v83
    v_mul_f32 v118, v118, v97
    v_mul_f32 v119, v119, v97
    v_cvt_pk_bf16_f32 v83, v118, v119
    ds_write_b128 v17, v[80:83] offset:0
    v_lshlrev_b32 v112, 16, v84
    v_and_b32 v113, 0xffff0000, v84
    v_mul_f32 v112, v112, v97
    v_mul_f32 v113, v113, v97
    v_cvt_pk_bf16_f32 v84, v112, v113
    v_lshlrev_b32 v114, 16, v85
    v_and_b32 v115, 0xffff0000, v85
    v_mul_f32 v114, v114, v97
    v_mul_f32 v115, v115, v97
    v_cvt_pk_bf16_f32 v85, v114, v115
    v_lshlrev_b32 v116, 16, v86
    v_and_b32 v117, 0xffff0000, v86
    v_mul_f32 v116, v116, v97
    v_mul_f32 v117, v117, v97
    v_cvt_pk_bf16_f32 v86, v116, v117
    v_lshlrev_b32 v118, 16, v87
    v_and_b32 v119, 0xffff0000, v87
    v_mul_f32 v118, v118, v97
    v_mul_f32 v119, v119, v97
    v_cvt_pk_bf16_f32 v87, v118, v119
    ds_write_b128 v17, v[84:87] offset:256
    v_lshlrev_b32 v112, 16, v88
    v_and_b32 v113, 0xffff0000, v88
    v_mul_f32 v112, v112, v97
    v_mul_f32 v113, v113, v97
    v_cvt_pk_bf16_f32 v88, v112, v113
    v_lshlrev_b32 v114, 16, v89
    v_and_b32 v115, 0xffff0000, v89
    v_mul_f32 v114, v114, v97
    v_mul_f32 v115, v115, v97
    v_cvt_pk_bf16_f32 v89, v114, v115
    v_lshlrev_b32 v116, 16, v90
    v_and_b32 v117, 0xffff0000, v90
    v_mul_f32 v116, v116, v97
    v_mul_f32 v117, v117, v97
    v_cvt_pk_bf16_f32 v90, v116, v117
    v_lshlrev_b32 v118, 16, v91
    v_and_b32 v119, 0xffff0000, v91
    v_mul_f32 v118, v118, v97
    v_mul_f32 v119, v119, v97
    v_cvt_pk_bf16_f32 v91, v118, v119
    v_lshlrev_b32 v112, 16, v92
    v_and_b32 v113, 0xffff0000, v92
    v_mul_f32 v112, v112, v97
    v_mul_f32 v113, v113, v97
    v_cvt_pk_bf16_f32 v92, v112, v113
    v_lshlrev_b32 v114, 16, v93
    v_and_b32 v115, 0xffff0000, v93
    v_mul_f32 v114, v114, v97
    v_mul_f32 v115, v115, v97
    v_cvt_pk_bf16_f32 v93, v114, v115
    v_lshlrev_b32 v116, 16, v94
    v_and_b32 v117, 0xffff0000, v94
    v_mul_f32 v116, v116, v97
    v_mul_f32 v117, v117, v97
    v_cvt_pk_bf16_f32 v94, v116, v117
    v_lshlrev_b32 v118, 16, v95
    v_and_b32 v119, 0xffff0000, v95
    v_mul_f32 v118, v118, v97
    v_mul_f32 v119, v119, v97
    v_cvt_pk_bf16_f32 v95, v118, v119
    s_mov_b32 s42, 3
    s_bitcmp0_b32 s42, s30
    s_cbranch_scc1 L_k1_pf0
    buffer_load_dword v6, v5, s[52:55], 0 offen
L_k1_pf0:
    s_waitcnt vmcnt(1) lgkmcnt(0)
    s_mov_b32 s42, 3
    s_bitcmp1_b32 s42, s30
    s_cbranch_scc1 L_k1_w1
    s_waitcnt vmcnt(0)
L_k1_w1:
    s_barrier
    s_mov_b32 s42, 12
    s_bitcmp0_b32 s42, s30
    s_cbranch_scc1 L_k1_pf1
    buffer_load_dword v6, v5, s[52:55], 0 offen
L_k1_pf1:
    ds_read_b128 v[96:99], v20 offset:0
    ds_read_b128 v[100:103], v20 offset:2048
    ds_read_b128 v[104:107], v24 offset:0
    ds_read_b128 v[108:111], v24 offset:4096
    ds_read_b128 v[112:115], v21 offset:0
    ds_read_b128 v[116:119], v21 offset:2048
    ds_read_b128 v[120:123], v25 offset:0
    ds_read_b128 v[124:127], v25 offset:4096
    s_waitcnt lgkmcnt(4)
    v_mfma_f32_16x16x32_bf16 v[32:35], v[96:99], v[104:107], 0
    v_mfma_f32_16x16x32_bf16 v[36:39], v[96:99], v[108:111], 0
    v_mfma_f32_16x16x32_bf16 v[40:43], v[100:103], v[104:107], 0
    v_mfma_f32_16x16x32_bf16 v[44:47], v[100:103], v[108:111], 0
    ds_read_b128 v[96:99], v22 offset:0
    ds_read_b128 v[100:103], v22 offset:2048
    ds_read_b128 v[104:107], v26 offset:0
    ds_read_b128 v[108:111], v26 offset:4096
    s_waitcnt lgkmcnt(4)
    v_mfma_f32_16x16x32_bf16 v[32:35], v[112:115], v[120:123], v[32:35]
    v_mfma_f32_16x16x32_bf16 v[36:39], v[112:115], v[124:127], v[36:39]
    v_mfma_f32_16x16x32_bf16 v[40:43], v[116:119], v[120:123], v[40:43]
    v_mfma_f32_16x16x32_bf16 v[44:47], v[116:119], v[124:127], v[44:47]
    ds_read_b128 v[112:115], v23 offset:0
    ds_read_b128 v[116:119], v23 offset:2048
    ds_read_b128 v[120:123], v27 offset:0
    ds_read_b128 v[124:127], v27 offset:4096
    s_waitcnt lgkmcnt(4)
    v_mfma_f32_16x16x32_bf16 v[32:35], v[96:99], v[104:107], v[32:35]
    v_mfma_f32_16x16x32_bf16 v[36:39], v[96:99], v[108:111], v[36:39]
    v_mfma_f32_16x16x32_bf16 v[40:43], v[100:103], v[104:107], v[40:43]
    v_mfma_f32_16x16x32_bf16 v[44:47], v[100:103], v[108:111], v[44:47]
    ds_read_b128 v[96:99], v20 offset:256
    ds_read_b128 v[100:103], v20 offset:2304
    ds_read_b128 v[104:107], v24 offset:256
    ds_read_b128 v[108:111], v24 offset:4352
    s_waitcnt lgkmcnt(4)
    v_mfma_f32_16x16x32_bf16 v[32:35], v[112:115], v[120:123], v[32:35]
    v_mfma_f32_16x16x32_bf16 v[36:39], v[112:115], v[124:127], v[36:39]
    v_mfma_f32_16x16x32_bf16 v[40:43], v[116:119], v[120:123], v[40:43]
    v_mfma_f32_16x16x32_bf16 v[44:47], v[116:119], v[124:127], v[44:47]
    ds_read_b128 v[112:115], v21 offset:256
    ds_read_b128 v[116:119], v21 offset:2304
    ds_read_b128 v[120:123], v25 offset:256
    ds_read_b128 v[124:127], v25 offset:4352
    s_waitcnt lgkmcnt(4)
    v_mfma_f32_16x16x32_bf16 v[32:35], v[96:99], v[104:107], v[32:35]
    v_mfma_f32_16x16x32_bf16 v[36:39], v[96:99], v[108:111], v[36:39]
    v_mfma_f32_16x16x32_bf16 v[40:43], v[100:103], v[104:107], v[40:43]
    v_mfma_f32_16x16x32_bf16 v[44:47], v[100:103], v[108:111], v[44:47]
    ds_read_b128 v[96:99], v22 offset:256
    ds_read_b128 v[100:103], v22 offset:2304
    ds_read_b128 v[104:107], v26 offset:256
    ds_read_b128 v[108:111], v26 offset:4352
    s_waitcnt lgkmcnt(4)
    v_mfma_f32_16x16x32_bf16 v[32:35], v[112:115], v[120:123], v[32:35]
    v_mfma_f32_16x16x32_bf16 v[36:39], v[112:115], v[124:127], v[36:39]
    v_mfma_f32_16x16x32_bf16 v[40:43], v[116:119], v[120:123], v[40:43]
    v_mfma_f32_16x16x32_bf16 v[44:47], v[116:119], v[124:127], v[44:47]
    ds_read_b128 v[112:115], v23 offset:256
    ds_read_b128 v[116:119], v23 offset:2304
    ds_read_b128 v[120:123], v27 offset:256
    ds_read_b128 v[124:127], v27 offset:4352
    s_waitcnt lgkmcnt(4)
    v_mfma_f32_16x16x32_bf16 v[32:35], v[96:99], v[104:107], v[32:35]
    v_mfma_f32_16x16x32_bf16 v[36:39], v[96:99], v[108:111], v[36:39]
    v_mfma_f32_16x16x32_bf16 v[40:43], v[100:103], v[104:107], v[40:43]
    v_mfma_f32_16x16x32_bf16 v[44:47], v[100:103], v[108:111], v[44:47]
    s_waitcnt lgkmcnt(0)
    v_mfma_f32_16x16x32_bf16 v[32:35], v[112:115], v[120:123], v[32:35]
    v_mfma_f32_16x16x32_bf16 v[36:39], v[112:115], v[124:127], v[36:39]
    v_mfma_f32_16x16x32_bf16 v[40:43], v[116:119], v[120:123], v[40:43]
    v_mfma_f32_16x16x32_bf16 v[44:47], v[116:119], v[124:127], v[44:47]
    s_barrier
    ds_write_b128 v16, v[72:75] offset:0
    ds_write_b128 v16, v[76:79] offset:256
    ds_write_b128 v17, v[88:91] offset:0
    ds_write_b128 v17, v[92:95] offset:256
    s_waitcnt lgkmcnt(0)
    s_barrier
    ds_read_b128 v[96:99], v20 offset:0
    ds_read_b128 v[100:103], v20 offset:2048
    ds_read_b128 v[104:107], v24 offset:512
    ds_read_b128 v[108:111], v24 offset:4608
    ds_read_b128 v[112:115], v21 offset:0
    ds_read_b128 v[116:119], v21 offset:2048
    ds_read_b128 v[120:123], v25 offset:512
    ds_read_b128 v[124:127], v25 offset:4608
    s_waitcnt lgkmcnt(4)
    v_mfma_f32_16x16x32_bf16 v[32:35], v[96:99], v[104:107], v[32:35]
    v_mfma_f32_16x16x32_bf16 v[36:39], v[96:99], v[108:111], v[36:39]
    v_mfma_f32_16x16x32_bf16 v[40:43], v[100:103], v[104:107], v[40:43]
    v_mfma_f32_16x16x32_bf16 v[44:47], v[100:103], v[108:111], v[44:47]
    ds_read_b128 v[96:99], v22 offset:0
    ds_read_b128 v[100:103], v22 offset:2048
    ds_read_b128 v[104:107], v26 offset:512
    ds_read_b128 v[108:111], v26 offset:4608
    s_waitcnt lgkmcnt(4)
    v_mfma_f32_16x16x32_bf16 v[32:35], v[112:115], v[120:123], v[32:35]
    v_mfma_f32_16x16x32_bf16 v[36:39], v[112:115], v[124:127], v[36:39]
    v_mfma_f32_16x16x32_bf16 v[40:43], v[116:119], v[120:123], v[40:43]
    v_mfma_f32_16x16x32_bf16 v[44:47], v[116:119], v[124:127], v[44:47]
    ds_read_b128 v[112:115], v23 offset:0
    ds_read_b128 v[116:119], v23 offset:2048
    ds_read_b128 v[120:123], v27 offset:512
    ds_read_b128 v[124:127], v27 offset:4608
    s_waitcnt lgkmcnt(4)
    v_mfma_f32_16x16x32_bf16 v[32:35], v[96:99], v[104:107], v[32:35]
    v_mfma_f32_16x16x32_bf16 v[36:39], v[96:99], v[108:111], v[36:39]
    v_mfma_f32_16x16x32_bf16 v[40:43], v[100:103], v[104:107], v[40:43]
    v_mfma_f32_16x16x32_bf16 v[44:47], v[100:103], v[108:111], v[44:47]
    ds_read_b128 v[96:99], v20 offset:256
    ds_read_b128 v[100:103], v20 offset:2304
    ds_read_b128 v[104:107], v24 offset:768
    ds_read_b128 v[108:111], v24 offset:4864
    s_waitcnt lgkmcnt(4)
    v_mfma_f32_16x16x32_bf16 v[32:35], v[112:115], v[120:123], v[32:35]
    v_mfma_f32_16x16x32_bf16 v[36:39], v[112:115], v[124:127], v[36:39]
    v_mfma_f32_16x16x32_bf16 v[40:43], v[116:119], v[120:123], v[40:43]
    v_mfma_f32_16x16x32_bf16 v[44:47], v[116:119], v[124:127], v[44:47]
    ds_read_b128 v[112:115], v21 offset:256
    ds_read_b128 v[116:119], v21 offset:2304
    ds_read_b128 v[120:123], v25 offset:768
    ds_read_b128 v[124:127], v25 offset:4864
    s_waitcnt lgkmcnt(4)
    v_mfma_f32_16x16x32_bf16 v[32:35], v[96:99], v[104:107], v[32:35]
    v_mfma_f32_16x16x32_bf16 v[36:39], v[96:99], v[108:111], v[36:39]
    v_mfma_f32_16x16x32_bf16 v[40:43], v[100:103], v[104:107], v[40:43]
    v_mfma_f32_16x16x32_bf16 v[44:47], v[100:103], v[108:111], v[44:47]
    ds_read_b128 v[96:99], v22 offset:256
    ds_read_b128 v[100:103], v22 offset:2304
    ds_read_b128 v[104:107], v26 offset:768
    ds_read_b128 v[108:111], v26 offset:4864
    s_waitcnt lgkmcnt(4)
    v_mfma_f32_16x16x32_bf16 v[32:35], v[112:115], v[120:123], v[32:35]
    v_mfma_f32_16x16x32_bf16 v[36:39], v[112:115], v[124:127], v[36:39]
    v_mfma_f32_16x16x32_bf16 v[40:43], v[116:119], v[120:123], v[40:43]
    v_mfma_f32_16x16x32_bf16 v[44:47], v[116:119], v[124:127], v[44:47]
    ds_read_b128 v[112:115], v23 offset:256
    ds_read_b128 v[116:119], v23 offset:2304
    ds_read_b128 v[120:123], v27 offset:768
    ds_read_b128 v[124:127], v27 offset:4864
    s_waitcnt lgkmcnt(4)
    v_mfma_f32_16x16x32_bf16 v[32:35], v[96:99], v[104:107], v[32:35]
    v_mfma_f32_16x16x32_bf16 v[36:39], v[96:99], v[108:111], v[36:39]
    v_mfma_f32_16x16x32_bf16 v[40:43], v[100:103], v[104:107], v[40:43]
    v_mfma_f32_16x16x32_bf16 v[44:47], v[100:103], v[108:111], v[44:47]
    s_waitcnt lgkmcnt(0)
    v_mfma_f32_16x16x32_bf16 v[32:35], v[112:115], v[120:123], v[32:35]
    v_mfma_f32_16x16x32_bf16 v[36:39], v[112:115], v[124:127], v[36:39]
    v_mfma_f32_16x16x32_bf16 v[40:43], v[116:119], v[120:123], v[40:43]
    v_mfma_f32_16x16x32_bf16 v[44:47], v[116:119], v[124:127], v[44:47]
    s_nop 7
    s_nop 1
    v_cvt_pk_bf16_f32 v96, v32, v33
    v_cvt_pk_bf16_f32 v97, v34, v35
    v_cvt_pk_bf16_f32 v98, v40, v41
    v_cvt_pk_bf16_f32 v99, v42, v43
    buffer_store_dwordx4 v[96:99], v3, s[56:59], 0 offen offset:0
    v_cvt_pk_bf16_f32 v100, v36, v37
    v_cvt_pk_bf16_f32 v101, v38, v39
    v_cvt_pk_bf16_f32 v102, v44, v45
    v_cvt_pk_bf16_f32 v103, v46, v47
    buffer_store_dwordx4 v[100:103], v3, s[56:59], 0 offen offset:2048
L_k1_end:
    s_endpgm
.globl k2_gemm_kernel
.p2align 8
.type k2_gemm_kernel,@function
k2_gemm_kernel:
    s_cmp_ge_u32 s2, 256
    s_cbranch_scc1 L_k2_end
    s_load_dwordx4 s[4:7], s[0:1], 8
    s_load_dwordx2 s[12:13], s[0:1], 96
    s_load_dwordx4 s[44:47], s[0:1], 56
    s_load_dwordx2 s[48:49], s[0:1], 72
    s_and_b32 s28, s2, 7
    s_lshr_b32 s29, s2, 3
    s_and_b32 s30, s28, 1
    s_lshr_b32 s31, s28, 1
    s_lshl_b32 s31, s31, 2
    s_lshr_b32 s32, s29, 3
    s_add_u32 s31, s31, s32
    s_and_b32 s32, s29, 7
    v_and_b32 v1, 63, v0
    v_lshrrev_b32 v2, 6, v0
    s_nop 0
    v_readfirstlane_b32 s33, v2
    v_and_b32 v12, 15, v1
    v_lshrrev_b32 v13, 4, v1
    v_and_b32 v14, 7, v1
    v_lshrrev_b32 v15, 3, v1
    s_lshl_b32 s34, s31, 7
    s_lshl_b32 s35, s33, 5
    s_add_u32 s34, s34, s35
    v_add_u32 v2, s34, v15
    v_lshlrev_b32 v2, 12, v2
    v_xor_b32 v3, v14, v15
    v_lshl_add_u32 v8, v3, 4, v2
    v_add_u32 v9, 0x7c00, v8
    v_add_u32 v10, 0xf800, v8
    v_add_u32 v11, 0x17400, v8
    v_lshlrev_b32 v5, 4, v1
    s_lshl_b32 s35, s33, 11
    v_add_u32 v4, s35, v5
    v_add_u32 v2, s34, v12
    v_lshlrev_b32 v6, 10, v2
    v_lshl_add_u32 v6, v13, 4, v6
    s_lshl_b32 s36, s30, 21
    s_lshl_b32 s37, s32, 7
    s_add_u32 s36, s36, s37
    v_add_u32 v6, s36, v6
    v_add_u32 v7, 0x4000, v6
    s_lshl_b32 s36, s33, 12
    v_lshlrev_b32 v2, 7, v12
    v_add_u32 v2, s36, v2
    v_xor_b32 v3, v13, v14
    v_lshl_add_u32 v16, v3, 4, v2
    v_xor_b32 v17, 64, v16
    v_add_u32 v18, 0x4000, v5
    v_add_u32 v19, 0xc000, v16
    v_add_u32 v20, 0xc000, v17
    v_add_u32 v21, 0xc000, v18
    v_add_u32 v22, 0x18000, v16
    v_add_u32 v23, 0x18000, v17
    v_add_u32 v24, 0x18000, v18
    s_waitcnt lgkmcnt(0)
    s_cmp_eq_u32 s30, 0
    s_cselect_b32 s8, s4, s6
    s_cselect_b32 s9, s5, s7
    s_and_b32 s9, s9, 0xffff
    s_mov_b32 s10, 0x800000
    s_mov_b32 s11, 0x00020000
    s_lshl_b32 s37, s30, 21
    s_lshl_b32 s38, s32, 18
    s_add_u32 s37, s37, s38
    s_add_u32 s16, s12, s37
    s_addc_u32 s17, s13, 0
    s_and_b32 s17, s17, 0xffff
    s_mov_b32 s18, 0x40000
    s_mov_b32 s19, 0x00020000
    s_add_u32 s37, s35, 16384
    s_add_u32 s20, s12, 0x400000
    s_addc_u32 s21, s13, 0
    s_and_b32 s21, s21, 0xffff
    s_mov_b32 s22, 0x700000
    s_mov_b32 s23, 0x00020000
    s_cmp_ge_u32 s2, 53
    s_cbranch_scc1 L_k2_nz
    s_cmp_lg_u32 s33, 0
    s_cbranch_scc1 L_k2_nz
    s_lshl_b32 s38, s2, 10
    s_add_u32 s39, s38, 6331392
    s_add_u32 s38, s38, 6553600
    s_cmp_lt_u32 s2, 25
    s_cselect_b32 s38, s38, s39
    s_cselect_b32 s39, 0, -1
    v_mov_b32 v32, s39
    v_mov_b32 v33, s39
    v_mov_b32 v34, s39
    v_mov_b32 v35, s39
    buffer_store_dwordx4 v[32:35], v5, s[20:23], s38 offen
    s_waitcnt vmcnt(0)
L_k2_nz:
    s_lshl_b32 s50, s29, 2
    s_add_u32 s50, s50, s33
    s_cmp_lt_u32 s50, 40
    s_cselect_b32 s52, s44, s46
    s_cselect_b32 s53, s45, s47
    s_cselect_b32 s51, 0, 40
    s_cmp_lt_u32 s50, 80
    s_cselect_b32 s52, s52, s48
    s_cselect_b32 s53, s53, s49
    s_cselect_b32 s51, s51, 80
    s_and_b32 s53, s53, 0xffff
    s_mov_b32 s54, 0x1c0000
    s_mov_b32 s55, 0x00020000
    s_sub_u32 s51, s50, s51
    s_lshl_b32 s51, s51, 6
    v_add_u32 v30, s51, v1
    s_mov_b32 s51, 52429
    v_mul_lo_u32 v31, v30, s51
    v_lshrrev_b32 v31, 18, v31
    v_mul_u32_u24 v29, 5, v31
    v_sub_u32 v29, v30, v29
    s_movk_i32 s51, 3584
    v_mul_lo_u32 v31, v31, s51
    v_lshl_add_u32 v31, v29, 7, v31
    s_mul_i32 s51, s28, 448
    s_and_b32 s51, s51, 0xffffff80
    v_add_u32 v31, s51, v31
    v_lshlrev_b32 v30, 10, v30
    s_lshl_b32 s51, s28, 7
    v_add_u32 v30, s51, v30
    s_cmp_lt_u32 s50, 80
    s_cselect_b64 vcc, -1, 0
    s_nop 1
    v_cndmask_b32 v30, v30, v31, vcc
    s_mul_i32 s42, s32, 4
    s_add_u32 s40, s36, 0
    s_mov_b32 m0, s40
    s_add_u32 s41, s42, 0
    s_and_b32 s41, s41, 31
    s_lshl_b32 s39, s41, 7
    buffer_load_dwordx4 v8, s[8:11], s39 offen lds
    buffer_load_dwordx4 v9, s[8:11], s39 offen offset:1024 lds
    buffer_load_dwordx4 v10, s[8:11], s39 offen offset:2048 lds
    buffer_load_dwordx4 v11, s[8:11], s39 offen offset:3072 lds
    s_add_u32 s40, s37, 0
    s_mov_b32 m0, s40
    s_lshl_b32 s38, s41, 13
    buffer_load_dwordx4 v4, s[16:19], s38 offen lds
    buffer_load_dwordx4 v4, s[16:19], s38 offen offset:1024 lds
    s_add_u32 s40, s36, 24576
    s_mov_b32 m0, s40
    s_add_u32 s41, s42, 1
    s_and_b32 s41, s41, 31
    s_lshl_b32 s39, s41, 7
    buffer_load_dwordx4 v8, s[8:11], s39 offen lds
    buffer_load_dwordx4 v9, s[8:11], s39 offen offset:1024 lds
    buffer_load_dwordx4 v10, s[8:11], s39 offen offset:2048 lds
    buffer_load_dwordx4 v11, s[8:11], s39 offen offset:3072 lds
    s_add_u32 s40, s37, 24576
    s_mov_b32 m0, s40
    s_lshl_b32 s38, s41, 13
    buffer_load_dwordx4 v4, s[16:19], s38 offen lds
    buffer_load_dwordx4 v4, s[16:19], s38 offen offset:1024 lds
    s_add_u32 s40, s36, 49152
    s_mov_b32 m0, s40
    s_add_u32 s41, s42, 2
    s_and_b32 s41, s41, 31
    s_lshl_b32 s39, s41, 7
    buffer_load_dwordx4 v8, s[8:11], s39 offen lds
    buffer_load_dwordx4 v9, s[8:11], s39 offen offset:1024 lds
    buffer_load_dwordx4 v10, s[8:11], s39 offen offset:2048 lds
    buffer_load_dwordx4 v11, s[8:11], s39 offen offset:3072 lds
    s_add_u32 s40, s37, 49152
    s_mov_b32 m0, s40
    s_lshl_b32 s38, s41, 13
    buffer_load_dwordx4 v4, s[16:19], s38 offen lds
    buffer_load_dwordx4 v4, s[16:19], s38 offen offset:1024 lds
    s_add_u32 s40, s36, 73728
    s_mov_b32 m0, s40
    s_add_u32 s41, s42, 3
    s_and_b32 s41, s41, 31
    s_lshl_b32 s39, s41, 7
    buffer_load_dwordx4 v8, s[8:11], s39 offen lds
    buffer_load_dwordx4 v9, s[8:11], s39 offen offset:1024 lds
    buffer_load_dwordx4 v10, s[8:11], s39 offen offset:2048 lds
    buffer_load_dwordx4 v11, s[8:11], s39 offen offset:3072 lds
    s_add_u32 s40, s37, 73728
    s_mov_b32 m0, s40
    s_lshl_b32 s38, s41, 13
    buffer_load_dwordx4 v4, s[16:19], s38 offen lds
    buffer_load_dwordx4 v4, s[16:19], s38 offen offset:1024 lds
    s_waitcnt vmcnt(18)
    s_barrier
    ds_read_b128 v[64:67], v18 offset:0
    ds_read_b128 v[68:71], v18 offset:2048
    ds_read_b128 v[72:75], v18 offset:4096
    ds_read_b128 v[76:79], v18 offset:6144
    ds_read_b128 v[96:99], v16 offset:0
    ds_read_b128 v[100:103], v16 offset:2048
    ds_read_b128 v[80:83], v18 offset:1024
    ds_read_b128 v[84:87], v18 offset:3072
    ds_read_b128 v[88:91], v18 offset:5120
    ds_read_b128 v[92:95], v18 offset:7168
    ds_read_b128 v[104:107], v17 offset:0
    ds_read_b128 v[108:111], v17 offset:2048
    s_waitcnt lgkmcnt(0)
    s_waitcnt vmcnt(12)
    s_barrier
    v_mfma_f32_16x16x32_bf16 v[32:35], v[64:67], v[96:99], 0
    ds_read_b128 v[112:115], v18 offset:24576
    s_add_u32 s40, s36, 98304
    s_mov_b32 m0, s40
    s_add_u32 s41, s42, 4
    s_and_b32 s41, s41, 31
    s_lshl_b32 s39, s41, 7
    buffer_load_dwordx4 v8, s[8:11], s39 offen lds
    v_mfma_f32_16x16x32_bf16 v[36:39], v[64:67], v[100:103], 0
    ds_read_b128 v[116:119], v18 offset:26624
    buffer_load_dwordx4 v9, s[8:11], s39 offen offset:1024 lds
    v_mfma_f32_16x16x32_bf16 v[40:43], v[68:71], v[96:99], 0
    ds_read_b128 v[120:123], v18 offset:28672
    buffer_load_dwordx4 v10, s[8:11], s39 offen offset:2048 lds
    v_mfma_f32_16x16x32_bf16 v[44:47], v[68:71], v[100:103], 0
    ds_read_b128 v[124:127], v18 offset:30720
    buffer_load_dwordx4 v11, s[8:11], s39 offen offset:3072 lds
    v_mfma_f32_16x16x32_bf16 v[48:51], v[72:75], v[96:99], 0
    ds_read_b128 v[144:147], v16 offset:24576
    s_add_u32 s40, s37, 98304
    s_mov_b32 m0, s40
    s_lshl_b32 s38, s41, 13
    buffer_load_dwordx4 v4, s[16:19], s38 offen lds
    v_mfma_f32_16x16x32_bf16 v[52:55], v[72:75], v[100:103], 0
    ds_read_b128 v[148:151], v16 offset:26624
    buffer_load_dwordx4 v4, s[16:19], s38 offen offset:1024 lds
    v_mfma_f32_16x16x32_bf16 v[56:59], v[76:79], v[96:99], 0
    ds_read_b128 v[128:131], v18 offset:25600
    s_add_u32 s40, s36, 122880
    s_mov_b32 m0, s40
    s_add_u32 s41, s42, 5
    s_and_b32 s41, s41, 31
    s_lshl_b32 s39, s41, 7
    buffer_load_dwordx4 v8, s[8:11], s39 offen lds
    v_mfma_f32_16x16x32_bf16 v[60:63], v[76:79], v[100:103], 0
    ds_read_b128 v[132:135], v18 offset:27648
    buffer_load_dwordx4 v9, s[8:11], s39 offen offset:1024 lds
    v_mfma_f32_16x16x32_bf16 v[32:35], v[80:83], v[104:107], v[32:35]
    ds_read_b128 v[136:139], v18 offset:29696
    buffer_load_dwordx4 v10, s[8:11], s39 offen offset:2048 lds
    v_mfma_f32_16x16x32_bf16 v[36:39], v[80:83], v[108:111], v[36:39]
    ds_read_b128 v[140:143], v18 offset:31744
    buffer_load_dwordx4 v11, s[8:11], s39 offen offset:3072 lds
    v_mfma_f32_16x16x32_bf16 v[40:43], v[84:87], v[104:107], v[40:43]
    ds_read_b128 v[152:155], v17 offset:24576
    s_add_u32 s40, s37, 122880
    s_mov_b32 m0, s40
    s_lshl_b32 s38, s41, 13
    buffer_load_dwordx4 v4, s[16:19], s38 offen lds
    v_mfma_f32_16x16x32_bf16 v[44:47], v[84:87], v[108:111], v[44:47]
    ds_read_b128 v[156:159], v17 offset:26624
    buffer_load_dwordx4 v4, s[16:19], s38 offen offset:1024 lds
    v_mfma_f32_16x16x32_bf16 v[48:51], v[88:91], v[104:107], v[48:51]
    v_mfma_f32_16x16x32_bf16 v[52:55], v[88:91], v[108:111], v[52:55]
    v_mfma_f32_16x16x32_bf16 v[56:59], v[92:95], v[104:107], v[56:59]
    v_mfma_f32_16x16x32_bf16 v[60:63], v[92:95], v[108:111], v[60:63]
    s_waitcnt lgkmcnt(0)
    s_waitcnt vmcnt(18)
    s_barrier
    v_mfma_f32_16x16x32_bf16 v[32:35], v[112:115], v[144:147], v[32:35]
    ds_read_b128 v[64:67], v21 offset:0
    s_add_u32 s40, s36, 0
    s_mov_b32 m0, s40
    s_add_u32 s41, s42, 6
    s_and_b32 s41, s41, 31
    s_lshl_b32 s39, s41, 7
    buffer_load_dwordx4 v8, s[8:11], s39 offen lds
    v_mfma_f32_16x16x32_bf16 v[36:39], v[112:115], v[148:151], v[36:39]
    ds_read_b128 v[68:71], v21 offset:2048
    buffer_load_dwordx4 v9, s[8:11], s39 offen offset:1024 lds
    v_mfma_f32_16x16x32_bf16 v[40:43], v[116:119], v[144:147], v[40:43]
    ds_read_b128 v[72:75], v21 offset:4096
    buffer_load_dwordx4 v10, s[8:11], s39 offen offset:2048 lds
    v_mfma_f32_16x16x32_bf16 v[44:47], v[116:119], v[148:151], v[44:47]
    ds_read_b128 v[76:79], v21 offset:6144
    buffer_load_dwordx4 v11, s[8:11], s39 offen offset:3072 lds
    v_mfma_f32_16x16x32_bf16 v[48:51], v[120:123], v[144:147], v[48:51]
    ds_read_b128 v[96:99], v19 offset:0
    s_add_u32 s40, s37, 0
    s_mov_b32 m0, s40
    s_lshl_b32 s38, s41, 13
    buffer_load_dwordx4 v4, s[16:19], s38 offen lds
    v_mfma_f32_16x16x32_bf16 v[52:55], v[120:123], v[148:151], v[52:55]
    ds_read_b128 v[100:103], v19 offset:2048
    buffer_load_dwordx4 v4, s[16:19], s38 offen offset:1024 lds
    v_mfma_f32_16x16x32_bf16 v[56:59], v[124:127], v[144:147], v[56:59]
    ds_read_b128 v[80:83], v21 offset:1024
    s_add_u32 s40, s36, 24576
    s_mov_b32 m0, s40
    s_add_u32 s41, s42, 7
    s_and_b32 s41, s41, 31
    s_lshl_b32 s39, s41, 7
    buffer_load_dwordx4 v8, s[8:11], s39 offen lds
    v_mfma_f32_16x16x32_bf16 v[60:63], v[124:127], v[148:151], v[60:63]
    ds_read_b128 v[84:87], v21 offset:3072
    buffer_load_dwordx4 v9, s[8:11], s39 offen offset:1024 lds
    v_mfma_f32_16x16x32_bf16 v[32:35], v[128:131], v[152:155], v[32:35]
    ds_read_b128 v[88:91], v21 offset:5120
    buffer_load_dwordx4 v10, s[8:11], s39 offen offset:2048 lds
    v_mfma_f32_16x16x32_bf16 v[36:39], v[128:131], v[156:159], v[36:39]
    ds_read_b128 v[92:95], v21 offset:7168
    buffer_load_dwordx4 v11, s[8:11], s39 offen offset:3072 lds
    v_mfma_f32_16x16x32_bf16 v[40:43], v[132:135], v[152:155], v[40:43]
    ds_read_b128 v[104:107], v20 offset:0
    s_add_u32 s40, s37, 24576
    s_mov_b32 m0, s40
    s_lshl_b32 s38, s41, 13
    buffer_load_dwordx4 v4, s[16:19], s38 offen lds
    v_mfma_f32_16x16x32_bf16 v[44:47], v[132:135], v[156:159], v[44:47]
    ds_read_b128 v[108:111], v20 offset:2048
    buffer_load_dwordx4 v4, s[16:19], s38 offen offset:1024 lds
    v_mfma_f32_16x16x32_bf16 v[48:51], v[136:139], v[152:155], v[48:51]
    v_mfma_f32_16x16x32_bf16 v[52:55], v[136:139], v[156:159], v[52:55]
    v_mfma_f32_16x16x32_bf16 v[56:59], v[140:143], v[152:155], v[56:59]
    v_mfma_f32_16x16x32_bf16 v[60:63], v[140:143], v[156:159], v[60:63]
    s_waitcnt lgkmcnt(0)
    s_waitcnt vmcnt(24)
    s_barrier
    v_mfma_f32_16x16x32_bf16 v[32:35], v[64:67], v[96:99], v[32:35]
    ds_read_b128 v[112:115], v21 offset:24576
    v_mfma_f32_16x16x32_bf16 v[36:39], v[64:67], v[100:103], v[36:39]
    ds_read_b128 v[116:119], v21 offset:26624
    s_add_u32 s40, s36, 49152
    s_mov_b32 m0, s40
    s_add_u32 s41, s42, 8
    s_and_b32 s41, s41, 31
    s_lshl_b32 s39, s41, 7
    buffer_load_dwordx4 v8, s[8:11], s39 offen lds
    v_mfma_f32_16x16x32_bf16 v[40:43], v[68:71], v[96:99], v[40:43]
    ds_read_b128 v[120:123], v21 offset:28672
    v_mfma_f32_16x16x32_bf16 v[44:47], v[68:71], v[100:103], v[44:47]
    ds_read_b128 v[124:127], v21 offset:30720
    buffer_load_dwordx4 v9, s[8:11], s39 offen offset:1024 lds
    v_mfma_f32_16x16x32_bf16 v[48:51], v[72:75], v[96:99], v[48:51]
    ds_read_b128 v[144:147], v19 offset:24576
    v_mfma_f32_16x16x32_bf16 v[52:55], v[72:75], v[100:103], v[52:55]
    ds_read_b128 v[148:151], v19 offset:26624
    v_mfma_f32_16x16x32_bf16 v[56:59], v[76:79], v[96:99], v[56:59]
    ds_read_b128 v[128:131], v21 offset:25600
    buffer_load_dwordx4 v10, s[8:11], s39 offen offset:2048 lds
    v_mfma_f32_16x16x32_bf16 v[60:63], v[76:79], v[100:103], v[60:63]
    ds_read_b128 v[132:135], v21 offset:27648
    v_mfma_f32_16x16x32_bf16 v[32:35], v[80:83], v[104:107], v[32:35]
    ds_read_b128 v[136:139], v21 offset:29696
    buffer_load_dwordx4 v11, s[8:11], s39 offen offset:3072 lds
    v_mfma_f32_16x16x32_bf16 v[36:39], v[80:83], v[108:111], v[36:39]
    ds_read_b128 v[140:143], v21 offset:31744
    v_mfma_f32_16x16x32_bf16 v[40:43], v[84:87], v[104:107], v[40:43]
    ds_read_b128 v[152:155], v20 offset:24576
    v_mfma_f32_16x16x32_bf16 v[44:47], v[84:87], v[108:111], v[44:47]
    ds_read_b128 v[156:159], v20 offset:26624
    s_add_u32 s40, s37, 49152
    s_mov_b32 m0, s40
    s_lshl_b32 s38, s41, 13
    buffer_load_dwordx4 v4, s[16:19], s38 offen lds
    v_mfma_f32_16x16x32_bf16 v[48:51], v[88:91], v[104:107], v[48:51]
    v_mfma_f32_16x16x32_bf16 v[52:55], v[88:91], v[108:111], v[52:55]
    buffer_load_dwordx4 v4, s[16:19], s38 offen offset:1024 lds
    v_mfma_f32_16x16x32_bf16 v[56:59], v[92:95], v[104:107], v[56:59]
    v_mfma_f32_16x16x32_bf16 v[60:63], v[92:95], v[108:111], v[60:63]
    s_waitcnt lgkmcnt(0)
    s_waitcnt vmcnt(24)
    s_barrier
    v_mfma_f32_16x16x32_bf16 v[32:35], v[112:115], v[144:147], v[32:35]
    ds_read_b128 v[64:67], v24 offset:0
    v_mfma_f32_16x16x32_bf16 v[36:39], v[112:115], v[148:151], v[36:39]
    ds_read_b128 v[68:71], v24 offset:2048
    s_add_u32 s40, s36, 73728
    s_mov_b32 m0, s40
    s_add_u32 s41, s42, 9
    s_and_b32 s41, s41, 31
    s_lshl_b32 s39, s41, 7
    buffer_load_dwordx4 v8, s[8:11], s39 offen lds
    v_mfma_f32_16x16x32_bf16 v[40:43], v[116:119], v[144:147], v[40:43]
    ds_read_b128 v[72:75], v24 offset:4096
    v_mfma_f32_16x16x32_bf16 v[44:47], v[116:119], v[148:151], v[44:47]
    ds_read_b128 v[76:79], v24 offset:6144
    buffer_load_dwordx4 v9, s[8:11], s39 offen offset:1024 lds
    v_mfma_f32_16x16x32_bf16 v[48:51], v[120:123], v[144:147], v[48:51]
    ds_read_b128 v[96:99], v22 offset:0
    v_mfma_f32_16x16x32_bf16 v[52:55], v[120:123], v[148:151], v[52:55]
    ds_read_b128 v[100:103], v22 offset:2048
    v_mfma_f32_16x16x32_bf16 v[56:59], v[124:127], v[144:147], v[56:59]
    ds_read_b128 v[80:83], v24 offset:1024
    buffer_load_dwordx4 v10, s[8:11], s39 offen offset:2048 lds
    v_mfma_f32_16x16x32_bf16 v[60:63], v[124:127], v[148:151], v[60:63]
    ds_read_b128 v[84:87], v24 offset:3072
    v_mfma_f32_16x16x32_bf16 v[32:35], v[128:131], v[152:155], v[32:35]
    ds_read_b128 v[88:91], v24 offset:5120
    buffer_load_dwordx4 v11, s[8:11], s39 offen offset:3072 lds
    v_mfma_f32_16x16x32_bf16 v[36:39], v[128:131], v[156:159], v[36:39]
    ds_read_b128 v[92:95], v24 offset:7168
    v_mfma_f32_16x16x32_bf16 v[40:43], v[132:135], v[152:155], v[40:43]
    ds_read_b128 v[104:107], v23 offset:0
    v_mfma_f32_16x16x32_bf16 v[44:47], v[132:135], v[156:159], v[44:47]
    ds_read_b128 v[108:111], v23 offset:2048
    s_add_u32 s40, s37, 73728
    s_mov_b32 m0, s40
    s_lshl_b32 s38, s41, 13
    buffer_load_dwordx4 v4, s[16:19], s38 offen lds
    v_mfma_f32_16x16x32_bf16 v[48:51], v[136:139], v[152:155], v[48:51]
    v_mfma_f32_16x16x32_bf16 v[52:55], v[136:139], v[156:159], v[52:55]
    buffer_load_dwordx4 v4, s[16:19], s38 offen offset:1024 lds
    v_mfma_f32_16x16x32_bf16 v[56:59], v[140:143], v[152:155], v[56:59]
    v_mfma_f32_16x16x32_bf16 v[60:63], v[140:143], v[156:159], v[60:63]
    s_waitcnt lgkmcnt(0)
    s_waitcnt vmcnt(24)
    s_barrier
    v_mfma_f32_16x16x32_bf16 v[32:35], v[64:67], v[96:99], v[32:35]
    ds_read_b128 v[112:115], v24 offset:24576
    v_mfma_f32_16x16x32_bf16 v[36:39], v[64:67], v[100:103], v[36:39]
    ds_read_b128 v[116:119], v24 offset:26624
    s_add_u32 s40, s36, 98304
    s_mov_b32 m0, s40
    s_add_u32 s41, s42, 10
    s_and_b32 s41, s41, 31
    s_lshl_b32 s39, s41, 7
    buffer_load_dwordx4 v8, s[8:11], s39 offen lds
    v_mfma_f32_16x16x32_bf16 v[40:43], v[68:71], v[96:99], v[40:43]
    ds_read_b128 v[120:123], v24 offset:28672
    v_mfma_f32_16x16x32_bf16 v[44:47], v[68:71], v[100:103], v[44:47]
    ds_read_b128 v[124:127], v24 offset:30720
    buffer_load_dwordx4 v9, s[8:11], s39 offen offset:1024 lds
    v_mfma_f32_16x16x32_bf16 v[48:51], v[72:75], v[96:99], v[48:51]
    ds_read_b128 v[144:147], v22 offset:24576
    v_mfma_f32_16x16x32_bf16 v[52:55], v[72:75], v[100:103], v[52:55]
    ds_read_b128 v[148:151], v22 offset:26624
    v_mfma_f32_16x16x32_bf16 v[56:59], v[76:79], v[96:99], v[56:59]
    ds_read_b128 v[128:131], v24 offset:25600
    buffer_load_dwordx4 v10, s[8:11], s39 offen offset:2048 lds
    v_mfma_f32_16x16x32_bf16 v[60:63], v[76:79], v[100:103], v[60:63]
    ds_read_b128 v[132:135], v24 offset:27648
    v_mfma_f32_16x16x32_bf16 v[32:35], v[80:83], v[104:107], v[32:35]
    ds_read_b128 v[136:139], v24 offset:29696
    buffer_load_dwordx4 v11, s[8:11], s39 offen offset:3072 lds
    v_mfma_f32_16x16x32_bf16 v[36:39], v[80:83], v[108:111], v[36:39]
    ds_read_b128 v[140:143], v24 offset:31744
    v_mfma_f32_16x16x32_bf16 v[40:43], v[84:87], v[104:107], v[40:43]
    ds_read_b128 v[152:155], v23 offset:24576
    v_mfma_f32_16x16x32_bf16 v[44:47], v[84:87], v[108:111], v[44:47]
    ds_read_b128 v[156:159], v23 offset:26624
    s_add_u32 s40, s37, 98304
    s_mov_b32 m0, s40
    s_lshl_b32 s38, s41, 13
    buffer_load_dwordx4 v4, s[16:19], s38 offen lds
    v_mfma_f32_16x16x32_bf16 v[48:51], v[88:91], v[104:107], v[48:51]
    v_mfma_f32_16x16x32_bf16 v[52:55], v[88:91], v[108:111], v[52:55]
    buffer_load_dwordx4 v4, s[16:19], s38 offen offset:1024 lds
    v_mfma_f32_16x16x32_bf16 v[56:59], v[92:95], v[104:107], v[56:59]
    v_mfma_f32_16x16x32_bf16 v[60:63], v[92:95], v[108:111], v[60:63]
    s_waitcnt lgkmcnt(0)
    s_waitcnt vmcnt(24)
    s_barrier
    v_mfma_f32_16x16x32_bf16 v[32:35], v[112:115], v[144:147], v[32:35]
    ds_read_b128 v[64:67], v18 offset:0
    v_mfma_f32_16x16x32_bf16 v[36:39], v[112:115], v[148:151], v[36:39]
    ds_read_b128 v[68:71], v18 offset:2048
    s_add_u32 s40, s36, 122880
    s_mov_b32 m0, s40
    s_add_u32 s41, s42, 11
    s_and_b32 s41, s41, 31
    s_lshl_b32 s39, s41, 7
    buffer_load_dwordx4 v8, s[8:11], s39 offen lds
    v_mfma_f32_16x16x32_bf16 v[40:43], v[116:119], v[144:147], v[40:43]
    ds_read_b128 v[72:75], v18 offset:4096
    v_mfma_f32_16x16x32_bf16 v[44:47], v[116:119], v[148:151], v[44:47]
    ds_read_b128 v[76:79], v18 offset:6144
    buffer_load_dwordx4 v9, s[8:11], s39 offen offset:1024 lds
    v_mfma_f32_16x16x32_bf16 v[48:51], v[120:123], v[144:147], v[48:51]
    ds_read_b128 v[96:99], v16 offset:0
    v_mfma_f32_16x16x32_bf16 v[52:55], v[120:123], v[148:151], v[52:55]
    ds_read_b128 v[100:103], v16 offset:2048
    v_mfma_f32_16x16x32_bf16 v[56:59], v[124:127], v[144:147], v[56:59]
    ds_read_b128 v[80:83], v18 offset:1024
    buffer_load_dwordx4 v10, s[8:11], s39 offen offset:2048 lds
    v_mfma_f32_16x16x32_bf16 v[60:63], v[124:127], v[148:151], v[60:63]
    ds_read_b128 v[84:87], v18 offset:3072
    v_mfma_f32_16x16x32_bf16 v[32:35], v[128:131], v[152:155], v[32:35]
    ds_read_b128 v[88:91], v18 offset:5120
    buffer_load_dwordx4 v11, s[8:11], s39 offen offset:3072 lds
    v_mfma_f32_16x16x32_bf16 v[36:39], v[128:131], v[156:159], v[36:39]
    ds_read_b128 v[92:95], v18 offset:7168
    v_mfma_f32_16x16x32_bf16 v[40:43], v[132:135], v[152:155], v[40:43]
    ds_read_b128 v[104:107], v17 offset:0
    v_mfma_f32_16x16x32_bf16 v[44:47], v[132:135], v[156:159], v[44:47]
    ds_read_b128 v[108:111], v17 offset:2048
    s_add_u32 s40, s37, 122880
    s_mov_b32 m0, s40
    s_lshl_b32 s38, s41, 13
    buffer_load_dwordx4 v4, s[16:19], s38 offen lds
    v_mfma_f32_16x16x32_bf16 v[48:51], v[136:139], v[152:155], v[48:51]
    v_mfma_f32_16x16x32_bf16 v[52:55], v[136:139], v[156:159], v[52:55]
    buffer_load_dwordx4 v4, s[16:19], s38 offen offset:1024 lds
    v_mfma_f32_16x16x32_bf16 v[56:59], v[140:143], v[152:155], v[56:59]
    v_mfma_f32_16x16x32_bf16 v[60:63], v[140:143], v[156:159], v[60:63]
    s_waitcnt lgkmcnt(0)
    s_waitcnt vmcnt(24)
    s_barrier
    v_mfma_f32_16x16x32_bf16 v[32:35], v[64:67], v[96:99], v[32:35]
    ds_read_b128 v[112:115], v18 offset:24576
    v_mfma_f32_16x16x32_bf16 v[36:39], v[64:67], v[100:103], v[36:39]
    ds_read_b128 v[116:119], v18 offset:26624
    s_add_u32 s40, s36, 0
    s_mov_b32 m0, s40
    s_add_u32 s41, s42, 12
    s_and_b32 s41, s41, 31
    s_lshl_b32 s39, s41, 7
    buffer_load_dwordx4 v8, s[8:11], s39 offen lds
    v_mfma_f32_16x16x32_bf16 v[40:43], v[68:71], v[96:99], v[40:43]
    ds_read_b128 v[120:123], v18 offset:28672
    v_mfma_f32_16x16x32_bf16 v[44:47], v[68:71], v[100:103], v[44:47]
    ds_read_b128 v[124:127], v18 offset:30720
    buffer_load_dwordx4 v9, s[8:11], s39 offen offset:1024 lds
    v_mfma_f32_16x16x32_bf16 v[48:51], v[72:75], v[96:99], v[48:51]
    ds_read_b128 v[144:147], v16 offset:24576
    v_mfma_f32_16x16x32_bf16 v[52:55], v[72:75], v[100:103], v[52:55]
    ds_read_b128 v[148:151], v16 offset:26624
    v_mfma_f32_16x16x32_bf16 v[56:59], v[76:79], v[96:99], v[56:59]
    ds_read_b128 v[128:131], v18 offset:25600
    buffer_load_dwordx4 v10, s[8:11], s39 offen offset:2048 lds
    v_mfma_f32_16x16x32_bf16 v[60:63], v[76:79], v[100:103], v[60:63]
    ds_read_b128 v[132:135], v18 offset:27648
    v_mfma_f32_16x16x32_bf16 v[32:35], v[80:83], v[104:107], v[32:35]
    ds_read_b128 v[136:139], v18 offset:29696
    buffer_load_dwordx4 v11, s[8:11], s39 offen offset:3072 lds
    v_mfma_f32_16x16x32_bf16 v[36:39], v[80:83], v[108:111], v[36:39]
    ds_read_b128 v[140:143], v18 offset:31744
    v_mfma_f32_16x16x32_bf16 v[40:43], v[84:87], v[104:107], v[40:43]
    ds_read_b128 v[152:155], v17 offset:24576
    v_mfma_f32_16x16x32_bf16 v[44:47], v[84:87], v[108:111], v[44:47]
    ds_read_b128 v[156:159], v17 offset:26624
    s_add_u32 s40, s37, 0
    s_mov_b32 m0, s40
    s_lshl_b32 s38, s41, 13
    buffer_load_dwordx4 v4, s[16:19], s38 offen lds
    v_mfma_f32_16x16x32_bf16 v[48:51], v[88:91], v[104:107], v[48:51]
    v_mfma_f32_16x16x32_bf16 v[52:55], v[88:91], v[108:111], v[52:55]
    buffer_load_dwordx4 v4, s[16:19], s38 offen offset:1024 lds
    v_mfma_f32_16x16x32_bf16 v[56:59], v[92:95], v[104:107], v[56:59]
    v_mfma_f32_16x16x32_bf16 v[60:63], v[92:95], v[108:111], v[60:63]
    s_waitcnt lgkmcnt(0)
    s_waitcnt vmcnt(24)
    s_barrier
    v_mfma_f32_16x16x32_bf16 v[32:35], v[112:115], v[144:147], v[32:35]
    ds_read_b128 v[64:67], v21 offset:0
    v_mfma_f32_16x16x32_bf16 v[36:39], v[112:115], v[148:151], v[36:39]
    ds_read_b128 v[68:71], v21 offset:2048
    s_add_u32 s40, s36, 24576
    s_mov_b32 m0, s40
    s_add_u32 s41, s42, 13
    s_and_b32 s41, s41, 31
    s_lshl_b32 s39, s41, 7
    buffer_load_dwordx4 v8, s[8:11], s39 offen lds
    v_mfma_f32_16x16x32_bf16 v[40:43], v[116:119], v[144:147], v[40:43]
    ds_read_b128 v[72:75], v21 offset:4096
    v_mfma_f32_16x16x32_bf16 v[44:47], v[116:119], v[148:151], v[44:47]
    ds_read_b128 v[76:79], v21 offset:6144
    buffer_load_dwordx4 v9, s[8:11], s39 offen offset:1024 lds
    v_mfma_f32_16x16x32_bf16 v[48:51], v[120:123], v[144:147], v[48:51]
    ds_read_b128 v[96:99], v19 offset:0
    v_mfma_f32_16x16x32_bf16 v[52:55], v[120:123], v[148:151], v[52:55]
    ds_read_b128 v[100:103], v19 offset:2048
    v_mfma_f32_16x16x32_bf16 v[56:59], v[124:127], v[144:147], v[56:59]
    ds_read_b128 v[80:83], v21 offset:1024
    buffer_load_dwordx4 v10, s[8:11], s39 offen offset:2048 lds
    v_mfma_f32_16x16x32_bf16 v[60:63], v[124:127], v[148:151], v[60:63]
    ds_read_b128 v[84:87], v21 offset:3072
    v_mfma_f32_16x16x32_bf16 v[32:35], v[128:131], v[152:155], v[32:35]
    ds_read_b128 v[88:91], v21 offset:5120
    buffer_load_dwordx4 v11, s[8:11], s39 offen offset:3072 lds
    v_mfma_f32_16x16x32_bf16 v[36:39], v[128:131], v[156:159], v[36:39]
    ds_read_b128 v[92:95], v21 offset:7168
    v_mfma_f32_16x16x32_bf16 v[40:43], v[132:135], v[152:155], v[40:43]
    ds_read_b128 v[104:107], v20 offset:0
    v_mfma_f32_16x16x32_bf16 v[44:47], v[132:135], v[156:159], v[44:47]
    ds_read_b128 v[108:111], v20 offset:2048
    s_add_u32 s40, s37, 24576
    s_mov_b32 m0, s40
    s_lshl_b32 s38, s41, 13
    buffer_load_dwordx4 v4, s[16:19], s38 offen lds
    v_mfma_f32_16x16x32_bf16 v[48:51], v[136:139], v[152:155], v[48:51]
    v_mfma_f32_16x16x32_bf16 v[52:55], v[136:139], v[156:159], v[52:55]
    buffer_load_dwordx4 v4, s[16:19], s38 offen offset:1024 lds
    v_mfma_f32_16x16x32_bf16 v[56:59], v[140:143], v[152:155], v[56:59]
    v_mfma_f32_16x16x32_bf16 v[60:63], v[140:143], v[156:159], v[60:63]
    s_waitcnt lgkmcnt(0)
    s_waitcnt vmcnt(24)
    s_barrier
    v_mfma_f32_16x16x32_bf16 v[32:35], v[64:67], v[96:99], v[32:35]
    ds_read_b128 v[112:115], v21 offset:24576
    v_mfma_f32_16x16x32_bf16 v[36:39], v[64:67], v[100:103], v[36:39]
    ds_read_b128 v[116:119], v21 offset:26624
    s_add_u32 s40, s36, 49152
    s_mov_b32 m0, s40
    s_add_u32 s41, s42, 14
    s_and_b32 s41, s41, 31
    s_lshl_b32 s39, s41, 7
    buffer_load_dwordx4 v8, s[8:11], s39 offen lds
    v_mfma_f32_16x16x32_bf16 v[40:43], v[68:71], v[96:99], v[40:43]
    ds_read_b128 v[120:123], v21 offset:28672
    v_mfma_f32_16x16x32_bf16 v[44:47], v[68:71], v[100:103], v[44:47]
    ds_read_b128 v[124:127], v21 offset:30720
    buffer_load_dwordx4 v9, s[8:11], s39 offen offset:1024 lds
    v_mfma_f32_16x16x32_bf16 v[48:51], v[72:75], v[96:99], v[48:51]
    ds_read_b128 v[144:147], v19 offset:24576
    v_mfma_f32_16x16x32_bf16 v[52:55], v[72:75], v[100:103], v[52:55]
    ds_read_b128 v[148:151], v19 offset:26624
    v_mfma_f32_16x16x32_bf16 v[56:59], v[76:79], v[96:99], v[56:59]
    ds_read_b128 v[128:131], v21 offset:25600
    buffer_load_dwordx4 v10, s[8:11], s39 offen offset:2048 lds
    v_mfma_f32_16x16x32_bf16 v[60:63], v[76:79], v[100:103], v[60:63]
    ds_read_b128 v[132:135], v21 offset:27648
    v_mfma_f32_16x16x32_bf16 v[32:35], v[80:83], v[104:107], v[32:35]
    ds_read_b128 v[136:139], v21 offset:29696
    buffer_load_dwordx4 v11, s[8:11], s39 offen offset:3072 lds
    v_mfma_f32_16x16x32_bf16 v[36:39], v[80:83], v[108:111], v[36:39]
    ds_read_b128 v[140:143], v21 offset:31744
    v_mfma_f32_16x16x32_bf16 v[40:43], v[84:87], v[104:107], v[40:43]
    ds_read_b128 v[152:155], v20 offset:24576
    v_mfma_f32_16x16x32_bf16 v[44:47], v[84:87], v[108:111], v[44:47]
    ds_read_b128 v[156:159], v20 offset:26624
    s_add_u32 s40, s37, 49152
    s_mov_b32 m0, s40
    s_lshl_b32 s38, s41, 13
    buffer_load_dwordx4 v4, s[16:19], s38 offen lds
    v_mfma_f32_16x16x32_bf16 v[48:51], v[88:91], v[104:107], v[48:51]
    v_mfma_f32_16x16x32_bf16 v[52:55], v[88:91], v[108:111], v[52:55]
    buffer_load_dwordx4 v4, s[16:19], s38 offen offset:1024 lds
    v_mfma_f32_16x16x32_bf16 v[56:59], v[92:95], v[104:107], v[56:59]
    v_mfma_f32_16x16x32_bf16 v[60:63], v[92:95], v[108:111], v[60:63]
    s_waitcnt lgkmcnt(0)
    s_waitcnt vmcnt(24)
    s_barrier
    v_mfma_f32_16x16x32_bf16 v[32:35], v[112:115], v[144:147], v[32:35]
    ds_read_b128 v[64:67], v24 offset:0
    v_mfma_f32_16x16x32_bf16 v[36:39], v[112:115], v[148:151], v[36:39]
    ds_read_b128 v[68:71], v24 offset:2048
    s_add_u32 s40, s36, 73728
    s_mov_b32 m0, s40
    s_add_u32 s41, s42, 15
    s_and_b32 s41, s41, 31
    s_lshl_b32 s39, s41, 7
    buffer_load_dwordx4 v8, s[8:11], s39 offen lds
    v_mfma_f32_16x16x32_bf16 v[40:43], v[116:119], v[144:147], v[40:43]
    ds_read_b128 v[72:75], v24 offset:4096
    v_mfma_f32_16x16x32_bf16 v[44:47], v[116:119], v[148:151], v[44:47]
    ds_read_b128 v[76:79], v24 offset:6144
    buffer_load_dwordx4 v9, s[8:11], s39 offen offset:1024 lds
    v_mfma_f32_16x16x32_bf16 v[48:51], v[120:123], v[144:147], v[48:51]
    ds_read_b128 v[96:99], v22 offset:0
    v_mfma_f32_16x16x32_bf16 v[52:55], v[120:123], v[148:151], v[52:55]
    ds_read_b128 v[100:103], v22 offset:2048
    v_mfma_f32_16x16x32_bf16 v[56:59], v[124:127], v[144:147], v[56:59]
    ds_read_b128 v[80:83], v24 offset:1024
    buffer_load_dwordx4 v10, s[8:11], s39 offen offset:2048 lds
    v_mfma_f32_16x16x32_bf16 v[60:63], v[124:127], v[148:151], v[60:63]
    ds_read_b128 v[84:87], v24 offset:3072
    v_mfma_f32_16x16x32_bf16 v[32:35], v[128:131], v[152:155], v[32:35]
    ds_read_b128 v[88:91], v24 offset:5120
    buffer_load_dwordx4 v11, s[8:11], s39 offen offset:3072 lds
    v_mfma_f32_16x16x32_bf16 v[36:39], v[128:131], v[156:159], v[36:39]
    ds_read_b128 v[92:95], v24 offset:7168
    v_mfma_f32_16x16x32_bf16 v[40:43], v[132:135], v[152:155], v[40:43]
    ds_read_b128 v[104:107], v23 offset:0
    v_mfma_f32_16x16x32_bf16 v[44:47], v[132:135], v[156:159], v[44:47]
    ds_read_b128 v[108:111], v23 offset:2048
    s_add_u32 s40, s37, 73728
    s_mov_b32 m0, s40
    s_lshl_b32 s38, s41, 13
    buffer_load_dwordx4 v4, s[16:19], s38 offen lds
    v_mfma_f32_16x16x32_bf16 v[48:51], v[136:139], v[152:155], v[48:51]
    v_mfma_f32_16x16x32_bf16 v[52:55], v[136:139], v[156:159], v[52:55]
    buffer_load_dwordx4 v4, s[16:19], s38 offen offset:1024 lds
    v_mfma_f32_16x16x32_bf16 v[56:59], v[140:143], v[152:155], v[56:59]
    v_mfma_f32_16x16x32_bf16 v[60:63], v[140:143], v[156:159], v[60:63]
    s_waitcnt lgkmcnt(0)
    s_waitcnt vmcnt(24)
    s_barrier
    v_mfma_f32_16x16x32_bf16 v[32:35], v[64:67], v[96:99], v[32:35]
    ds_read_b128 v[112:115], v24 offset:24576
    v_mfma_f32_16x16x32_bf16 v[36:39], v[64:67], v[100:103], v[36:39]
    ds_read_b128 v[116:119], v24 offset:26624
    s_add_u32 s40, s36, 98304
    s_mov_b32 m0, s40
    s_add_u32 s41, s42, 16
    s_and_b32 s41, s41, 31
    s_lshl_b32 s39, s41, 7
    buffer_load_dwordx4 v8, s[8:11], s39 offen lds
    v_mfma_f32_16x16x32_bf16 v[40:43], v[68:71], v[96:99], v[40:43]
    ds_read_b128 v[120:123], v24 offset:28672
    v_mfma_f32_16x16x32_bf16 v[44:47], v[68:71], v[100:103], v[44:47]
    ds_read_b128 v[124:127], v24 offset:30720
    buffer_load_dwordx4 v9, s[8:11], s39 offen offset:1024 lds
    v_mfma_f32_16x16x32_bf16 v[48:51], v[72:75], v[96:99], v[48:51]
    ds_read_b128 v[144:147], v22 offset:24576
    v_mfma_f32_16x16x32_bf16 v[52:55], v[72:75], v[100:103], v[52:55]
    ds_read_b128 v[148:151], v22 offset:26624
    v_mfma_f32_16x16x32_bf16 v[56:59], v[76:79], v[96:99], v[56:59]
    ds_read_b128 v[128:131], v24 offset:25600
    buffer_load_dwordx4 v10, s[8:11], s39 offen offset:2048 lds
    v_mfma_f32_16x16x32_bf16 v[60:63], v[76:79], v[100:103], v[60:63]
    ds_read_b128 v[132:135], v24 offset:27648
    v_mfma_f32_16x16x32_bf16 v[32:35], v[80:83], v[104:107], v[32:35]
    ds_read_b128 v[136:139], v24 offset:29696
    buffer_load_dwordx4 v11, s[8:11], s39 offen offset:3072 lds
    v_mfma_f32_16x16x32_bf16 v[36:39], v[80:83], v[108:111], v[36:39]
    ds_read_b128 v[140:143], v24 offset:31744
    v_mfma_f32_16x16x32_bf16 v[40:43], v[84:87], v[104:107], v[40:43]
    ds_read_b128 v[152:155], v23 offset:24576
    v_mfma_f32_16x16x32_bf16 v[44:47], v[84:87], v[108:111], v[44:47]
    ds_read_b128 v[156:159], v23 offset:26624
    s_add_u32 s40, s37, 98304
    s_mov_b32 m0, s40
    s_lshl_b32 s38, s41, 13
    buffer_load_dwordx4 v4, s[16:19], s38 offen lds
    v_mfma_f32_16x16x32_bf16 v[48:51], v[88:91], v[104:107], v[48:51]
    v_mfma_f32_16x16x32_bf16 v[52:55], v[88:91], v[108:111], v[52:55]
    buffer_load_dwordx4 v4, s[16:19], s38 offen offset:1024 lds
    v_mfma_f32_16x16x32_bf16 v[56:59], v[92:95], v[104:107], v[56:59]
    v_mfma_f32_16x16x32_bf16 v[60:63], v[92:95], v[108:111], v[60:63]
    s_waitcnt lgkmcnt(0)
    s_waitcnt vmcnt(24)
    s_barrier
    v_mfma_f32_16x16x32_bf16 v[32:35], v[112:115], v[144:147], v[32:35]
    ds_read_b128 v[64:67], v18 offset:0
    v_mfma_f32_16x16x32_bf16 v[36:39], v[112:115], v[148:151], v[36:39]
    ds_read_b128 v[68:71], v18 offset:2048
    s_add_u32 s40, s36, 122880
    s_mov_b32 m0, s40
    s_add_u32 s41, s42, 17
    s_and_b32 s41, s41, 31
    s_lshl_b32 s39, s41, 7
    buffer_load_dwordx4 v8, s[8:11], s39 offen lds
    v_mfma_f32_16x16x32_bf16 v[40:43], v[116:119], v[144:147], v[40:43]
    ds_read_b128 v[72:75], v18 offset:4096
    v_mfma_f32_16x16x32_bf16 v[44:47], v[116:119], v[148:151], v[44:47]
    ds_read_b128 v[76:79], v18 offset:6144
    buffer_load_dwordx4 v9, s[8:11], s39 offen offset:1024 lds
    v_mfma_f32_16x16x32_bf16 v[48:51], v[120:123], v[144:147], v[48:51]
    ds_read_b128 v[96:99], v16 offset:0
    v_mfma_f32_16x16x32_bf16 v[52:55], v[120:123], v[148:151], v[52:55]
    ds_read_b128 v[100:103], v16 offset:2048
    v_mfma_f32_16x16x32_bf16 v[56:59], v[124:127], v[144:147], v[56:59]
    ds_read_b128 v[80:83], v18 offset:1024
    buffer_load_dwordx4 v10, s[8:11], s39 offen offset:2048 lds
    v_mfma_f32_16x16x32_bf16 v[60:63], v[124:127], v[148:151], v[60:63]
    ds_read_b128 v[84:87], v18 offset:3072
    v_mfma_f32_16x16x32_bf16 v[32:35], v[128:131], v[152:155], v[32:35]
    ds_read_b128 v[88:91], v18 offset:5120
    buffer_load_dwordx4 v11, s[8:11], s39 offen offset:3072 lds
    v_mfma_f32_16x16x32_bf16 v[36:39], v[128:131], v[156:159], v[36:39]
    ds_read_b128 v[92:95], v18 offset:7168
    v_mfma_f32_16x16x32_bf16 v[40:43], v[132:135], v[152:155], v[40:43]
    ds_read_b128 v[104:107], v17 offset:0
    v_mfma_f32_16x16x32_bf16 v[44:47], v[132:135], v[156:159], v[44:47]
    ds_read_b128 v[108:111], v17 offset:2048
    s_add_u32 s40, s37, 122880
    s_mov_b32 m0, s40
    s_lshl_b32 s38, s41, 13
    buffer_load_dwordx4 v4, s[16:19], s38 offen lds
    v_mfma_f32_16x16x32_bf16 v[48:51], v[136:139], v[152:155], v[48:51]
    v_mfma_f32_16x16x32_bf16 v[52:55], v[136:139], v[156:159], v[52:55]
    buffer_load_dwordx4 v4, s[16:19], s38 offen offset:1024 lds
    v_mfma_f32_16x16x32_bf16 v[56:59], v[140:143], v[152:155], v[56:59]
    v_mfma_f32_16x16x32_bf16 v[60:63], v[140:143], v[156:159], v[60:63]
    s_waitcnt lgkmcnt(0)
    s_waitcnt vmcnt(24)
    s_barrier
    v_mfma_f32_16x16x32_bf16 v[32:35], v[64:67], v[96:99], v[32:35]
    ds_read_b128 v[112:115], v18 offset:24576
    v_mfma_f32_16x16x32_bf16 v[36:39], v[64:67], v[100:103], v[36:39]
    ds_read_b128 v[116:119], v18 offset:26624
    s_add_u32 s40, s36, 0
    s_mov_b32 m0, s40
    s_add_u32 s41, s42, 18
    s_and_b32 s41, s41, 31
    s_lshl_b32 s39, s41, 7
    buffer_load_dwordx4 v8, s[8:11], s39 offen lds
    v_mfma_f32_16x16x32_bf16 v[40:43], v[68:71], v[96:99], v[40:43]
    ds_read_b128 v[120:123], v18 offset:28672
    v_mfma_f32_16x16x32_bf16 v[44:47], v[68:71], v[100:103], v[44:47]
    ds_read_b128 v[124:127], v18 offset:30720
    buffer_load_dwordx4 v9, s[8:11], s39 offen offset:1024 lds
    v_mfma_f32_16x16x32_bf16 v[48:51], v[72:75], v[96:99], v[48:51]
    ds_read_b128 v[144:147], v16 offset:24576
    v_mfma_f32_16x16x32_bf16 v[52:55], v[72:75], v[100:103], v[52:55]
    ds_read_b128 v[148:151], v16 offset:26624
    v_mfma_f32_16x16x32_bf16 v[56:59], v[76:79], v[96:99], v[56:59]
    ds_read_b128 v[128:131], v18 offset:25600
    buffer_load_dwordx4 v10, s[8:11], s39 offen offset:2048 lds
    v_mfma_f32_16x16x32_bf16 v[60:63], v[76:79], v[100:103], v[60:63]
    ds_read_b128 v[132:135], v18 offset:27648
    v_mfma_f32_16x16x32_bf16 v[32:35], v[80:83], v[104:107], v[32:35]
    ds_read_b128 v[136:139], v18 offset:29696
    buffer_load_dwordx4 v11, s[8:11], s39 offen offset:3072 lds
    v_mfma_f32_16x16x32_bf16 v[36:39], v[80:83], v[108:111], v[36:39]
    ds_read_b128 v[140:143], v18 offset:31744
    v_mfma_f32_16x16x32_bf16 v[40:43], v[84:87], v[104:107], v[40:43]
    ds_read_b128 v[152:155], v17 offset:24576
    v_mfma_f32_16x16x32_bf16 v[44:47], v[84:87], v[108:111], v[44:47]
    ds_read_b128 v[156:159], v17 offset:26624
    s_add_u32 s40, s37, 0
    s_mov_b32 m0, s40
    s_lshl_b32 s38, s41, 13
    buffer_load_dwordx4 v4, s[16:19], s38 offen lds
    v_mfma_f32_16x16x32_bf16 v[48:51], v[88:91], v[104:107], v[48:51]
    v_mfma_f32_16x16x32_bf16 v[52:55], v[88:91], v[108:111], v[52:55]
    buffer_load_dwordx4 v4, s[16:19], s38 offen offset:1024 lds
    v_mfma_f32_16x16x32_bf16 v[56:59], v[92:95], v[104:107], v[56:59]
    v_mfma_f32_16x16x32_bf16 v[60:63], v[92:95], v[108:111], v[60:63]
    s_waitcnt lgkmcnt(0)
    s_waitcnt vmcnt(24)
    s_barrier
    v_mfma_f32_16x16x32_bf16 v[32:35], v[112:115], v[144:147], v[32:35]
    ds_read_b128 v[64:67], v21 offset:0
    v_mfma_f32_16x16x32_bf16 v[36:39], v[112:115], v[148:151], v[36:39]
    ds_read_b128 v[68:71], v21 offset:2048
    s_add_u32 s40, s36, 24576
    s_mov_b32 m0, s40
    s_add_u32 s41, s42, 19
    s_and_b32 s41, s41, 31
    s_lshl_b32 s39, s41, 7
    buffer_load_dwordx4 v8, s[8:11], s39 offen lds
    v_mfma_f32_16x16x32_bf16 v[40:43], v[116:119], v[144:147], v[40:43]
    ds_read_b128 v[72:75], v21 offset:4096
    v_mfma_f32_16x16x32_bf16 v[44:47], v[116:119], v[148:151], v[44:47]
    ds_read_b128 v[76:79], v21 offset:6144
    buffer_load_dwordx4 v9, s[8:11], s39 offen offset:1024 lds
    v_mfma_f32_16x16x32_bf16 v[48:51], v[120:123], v[144:147], v[48:51]
    ds_read_b128 v[96:99], v19 offset:0
    v_mfma_f32_16x16x32_bf16 v[52:55], v[120:123], v[148:151], v[52:55]
    ds_read_b128 v[100:103], v19 offset:2048
    v_mfma_f32_16x16x32_bf16 v[56:59], v[124:127], v[144:147], v[56:59]
    ds_read_b128 v[80:83], v21 offset:1024
    buffer_load_dwordx4 v10, s[8:11], s39 offen offset:2048 lds
    v_mfma_f32_16x16x32_bf16 v[60:63], v[124:127], v[148:151], v[60:63]
    ds_read_b128 v[84:87], v21 offset:3072
    v_mfma_f32_16x16x32_bf16 v[32:35], v[128:131], v[152:155], v[32:35]
    ds_read_b128 v[88:91], v21 offset:5120
    buffer_load_dwordx4 v11, s[8:11], s39 offen offset:3072 lds
    v_mfma_f32_16x16x32_bf16 v[36:39], v[128:131], v[156:159], v[36:39]
    ds_read_b128 v[92:95], v21 offset:7168
    v_mfma_f32_16x16x32_bf16 v[40:43], v[132:135], v[152:155], v[40:43]
    ds_read_b128 v[104:107], v20 offset:0
    v_mfma_f32_16x16x32_bf16 v[44:47], v[132:135], v[156:159], v[44:47]
    ds_read_b128 v[108:111], v20 offset:2048
    s_add_u32 s40, s37, 24576
    s_mov_b32 m0, s40
    s_lshl_b32 s38, s41, 13
    buffer_load_dwordx4 v4, s[16:19], s38 offen lds
    v_mfma_f32_16x16x32_bf16 v[48:51], v[136:139], v[152:155], v[48:51]
    v_mfma_f32_16x16x32_bf16 v[52:55], v[136:139], v[156:159], v[52:55]
    buffer_load_dwordx4 v4, s[16:19], s38 offen offset:1024 lds
    v_mfma_f32_16x16x32_bf16 v[56:59], v[140:143], v[152:155], v[56:59]
    v_mfma_f32_16x16x32_bf16 v[60:63], v[140:143], v[156:159], v[60:63]
    s_waitcnt lgkmcnt(0)
    s_waitcnt vmcnt(24)
    s_barrier
    v_mfma_f32_16x16x32_bf16 v[32:35], v[64:67], v[96:99], v[32:35]
    ds_read_b128 v[112:115], v21 offset:24576
    v_mfma_f32_16x16x32_bf16 v[36:39], v[64:67], v[100:103], v[36:39]
    ds_read_b128 v[116:119], v21 offset:26624
    s_add_u32 s40, s36, 49152
    s_mov_b32 m0, s40
    s_add_u32 s41, s42, 20
    s_and_b32 s41, s41, 31
    s_lshl_b32 s39, s41, 7
    buffer_load_dwordx4 v8, s[8:11], s39 offen lds
    v_mfma_f32_16x16x32_bf16 v[40:43], v[68:71], v[96:99], v[40:43]
    ds_read_b128 v[120:123], v21 offset:28672
    v_mfma_f32_16x16x32_bf16 v[44:47], v[68:71], v[100:103], v[44:47]
    ds_read_b128 v[124:127], v21 offset:30720
    buffer_load_dwordx4 v9, s[8:11], s39 offen offset:1024 lds
    v_mfma_f32_16x16x32_bf16 v[48:51], v[72:75], v[96:99], v[48:51]
    ds_read_b128 v[144:147], v19 offset:24576
    v_mfma_f32_16x16x32_bf16 v[52:55], v[72:75], v[100:103], v[52:55]
    ds_read_b128 v[148:151], v19 offset:26624
    v_mfma_f32_16x16x32_bf16 v[56:59], v[76:79], v[96:99], v[56:59]
    ds_read_b128 v[128:131], v21 offset:25600
    buffer_load_dwordx4 v10, s[8:11], s39 offen offset:2048 lds
    v_mfma_f32_16x16x32_bf16 v[60:63], v[76:79], v[100:103], v[60:63]
    ds_read_b128 v[132:135], v21 offset:27648
    v_mfma_f32_16x16x32_bf16 v[32:35], v[80:83], v[104:107], v[32:35]
    ds_read_b128 v[136:139], v21 offset:29696
    buffer_load_dwordx4 v11, s[8:11], s39 offen offset:3072 lds
    v_mfma_f32_16x16x32_bf16 v[36:39], v[80:83], v[108:111], v[36:39]
    ds_read_b128 v[140:143], v21 offset:31744
    v_mfma_f32_16x16x32_bf16 v[40:43], v[84:87], v[104:107], v[40:43]
    ds_read_b128 v[152:155], v20 offset:24576
    v_mfma_f32_16x16x32_bf16 v[44:47], v[84:87], v[108:111], v[44:47]
    ds_read_b128 v[156:159], v20 offset:26624
    s_add_u32 s40, s37, 49152
    s_mov_b32 m0, s40
    s_lshl_b32 s38, s41, 13
    buffer_load_dwordx4 v4, s[16:19], s38 offen lds
    v_mfma_f32_16x16x32_bf16 v[48:51], v[88:91], v[104:107], v[48:51]
    v_mfma_f32_16x16x32_bf16 v[52:55], v[88:91], v[108:111], v[52:55]
    buffer_load_dwordx4 v4, s[16:19], s38 offen offset:1024 lds
    v_mfma_f32_16x16x32_bf16 v[56:59], v[92:95], v[104:107], v[56:59]
    v_mfma_f32_16x16x32_bf16 v[60:63], v[92:95], v[108:111], v[60:63]
    s_waitcnt lgkmcnt(0)
    s_waitcnt vmcnt(24)
    s_barrier
    v_mfma_f32_16x16x32_bf16 v[32:35], v[112:115], v[144:147], v[32:35]
    ds_read_b128 v[64:67], v24 offset:0
    v_mfma_f32_16x16x32_bf16 v[36:39], v[112:115], v[148:151], v[36:39]
    ds_read_b128 v[68:71], v24 offset:2048
    s_add_u32 s40, s36, 73728
    s_mov_b32 m0, s40
    s_add_u32 s41, s42, 21
    s_and_b32 s41, s41, 31
    s_lshl_b32 s39, s41, 7
    buffer_load_dwordx4 v8, s[8:11], s39 offen lds
    v_mfma_f32_16x16x32_bf16 v[40:43], v[116:119], v[144:147], v[40:43]
    ds_read_b128 v[72:75], v24 offset:4096
    v_mfma_f32_16x16x32_bf16 v[44:47], v[116:119], v[148:151], v[44:47]
    ds_read_b128 v[76:79], v24 offset:6144
    buffer_load_dwordx4 v9, s[8:11], s39 offen offset:1024 lds
    v_mfma_f32_16x16x32_bf16 v[48:51], v[120:123], v[144:147], v[48:51]
    ds_read_b128 v[96:99], v22 offset:0
    v_mfma_f32_16x16x32_bf16 v[52:55], v[120:123], v[148:151], v[52:55]
    ds_read_b128 v[100:103], v22 offset:2048
    v_mfma_f32_16x16x32_bf16 v[56:59], v[124:127], v[144:147], v[56:59]
    ds_read_b128 v[80:83], v24 offset:1024
    buffer_load_dwordx4 v10, s[8:11], s39 offen offset:2048 lds
    v_mfma_f32_16x16x32_bf16 v[60:63], v[124:127], v[148:151], v[60:63]
    ds_read_b128 v[84:87], v24 offset:3072
    v_mfma_f32_16x16x32_bf16 v[32:35], v[128:131], v[152:155], v[32:35]
    ds_read_b128 v[88:91], v24 offset:5120
    buffer_load_dwordx4 v11, s[8:11], s39 offen offset:3072 lds
    v_mfma_f32_16x16x32_bf16 v[36:39], v[128:131], v[156:159], v[36:39]
    ds_read_b128 v[92:95], v24 offset:7168
    v_mfma_f32_16x16x32_bf16 v[40:43], v[132:135], v[152:155], v[40:43]
    ds_read_b128 v[104:107], v23 offset:0
    v_mfma_f32_16x16x32_bf16 v[44:47], v[132:135], v[156:159], v[44:47]
    ds_read_b128 v[108:111], v23 offset:2048
    s_add_u32 s40, s37, 73728
    s_mov_b32 m0, s40
    s_lshl_b32 s38, s41, 13
    buffer_load_dwordx4 v4, s[16:19], s38 offen lds
    v_mfma_f32_16x16x32_bf16 v[48:51], v[136:139], v[152:155], v[48:51]
    v_mfma_f32_16x16x32_bf16 v[52:55], v[136:139], v[156:159], v[52:55]
    buffer_load_dwordx4 v4, s[16:19], s38 offen offset:1024 lds
    v_mfma_f32_16x16x32_bf16 v[56:59], v[140:143], v[152:155], v[56:59]
    v_mfma_f32_16x16x32_bf16 v[60:63], v[140:143], v[156:159], v[60:63]
    s_waitcnt lgkmcnt(0)
    s_waitcnt vmcnt(24)
    s_barrier
    v_mfma_f32_16x16x32_bf16 v[32:35], v[64:67], v[96:99], v[32:35]
    ds_read_b128 v[112:115], v24 offset:24576
    v_mfma_f32_16x16x32_bf16 v[36:39], v[64:67], v[100:103], v[36:39]
    ds_read_b128 v[116:119], v24 offset:26624
    s_add_u32 s40, s36, 98304
    s_mov_b32 m0, s40
    s_add_u32 s41, s42, 22
    s_and_b32 s41, s41, 31
    s_lshl_b32 s39, s41, 7
    buffer_load_dwordx4 v8, s[8:11], s39 offen lds
    v_mfma_f32_16x16x32_bf16 v[40:43], v[68:71], v[96:99], v[40:43]
    ds_read_b128 v[120:123], v24 offset:28672
    v_mfma_f32_16x16x32_bf16 v[44:47], v[68:71], v[100:103], v[44:47]
    ds_read_b128 v[124:127], v24 offset:30720
    buffer_load_dwordx4 v9, s[8:11], s39 offen offset:1024 lds
    v_mfma_f32_16x16x32_bf16 v[48:51], v[72:75], v[96:99], v[48:51]
    ds_read_b128 v[144:147], v22 offset:24576
    v_mfma_f32_16x16x32_bf16 v[52:55], v[72:75], v[100:103], v[52:55]
    ds_read_b128 v[148:151], v22 offset:26624
    v_mfma_f32_16x16x32_bf16 v[56:59], v[76:79], v[96:99], v[56:59]
    ds_read_b128 v[128:131], v24 offset:25600
    buffer_load_dwordx4 v10, s[8:11], s39 offen offset:2048 lds
    v_mfma_f32_16x16x32_bf16 v[60:63], v[76:79], v[100:103], v[60:63]
    ds_read_b128 v[132:135], v24 offset:27648
    v_mfma_f32_16x16x32_bf16 v[32:35], v[80:83], v[104:107], v[32:35]
    ds_read_b128 v[136:139], v24 offset:29696
    buffer_load_dwordx4 v11, s[8:11], s39 offen offset:3072 lds
    v_mfma_f32_16x16x32_bf16 v[36:39], v[80:83], v[108:111], v[36:39]
    ds_read_b128 v[140:143], v24 offset:31744
    v_mfma_f32_16x16x32_bf16 v[40:43], v[84:87], v[104:107], v[40:43]
    ds_read_b128 v[152:155], v23 offset:24576
    v_mfma_f32_16x16x32_bf16 v[44:47], v[84:87], v[108:111], v[44:47]
    ds_read_b128 v[156:159], v23 offset:26624
    s_add_u32 s40, s37, 98304
    s_mov_b32 m0, s40
    s_lshl_b32 s38, s41, 13
    buffer_load_dwordx4 v4, s[16:19], s38 offen lds
    v_mfma_f32_16x16x32_bf16 v[48:51], v[88:91], v[104:107], v[48:51]
    v_mfma_f32_16x16x32_bf16 v[52:55], v[88:91], v[108:111], v[52:55]
    buffer_load_dwordx4 v4, s[16:19], s38 offen offset:1024 lds
    v_mfma_f32_16x16x32_bf16 v[56:59], v[92:95], v[104:107], v[56:59]
    v_mfma_f32_16x16x32_bf16 v[60:63], v[92:95], v[108:111], v[60:63]
    s_waitcnt lgkmcnt(0)
    s_waitcnt vmcnt(24)
    s_barrier
    v_mfma_f32_16x16x32_bf16 v[32:35], v[112:115], v[144:147], v[32:35]
    ds_read_b128 v[64:67], v18 offset:0
    v_mfma_f32_16x16x32_bf16 v[36:39], v[112:115], v[148:151], v[36:39]
    ds_read_b128 v[68:71], v18 offset:2048
    s_add_u32 s40, s36, 122880
    s_mov_b32 m0, s40
    s_add_u32 s41, s42, 23
    s_and_b32 s41, s41, 31
    s_lshl_b32 s39, s41, 7
    buffer_load_dwordx4 v8, s[8:11], s39 offen lds
    v_mfma_f32_16x16x32_bf16 v[40:43], v[116:119], v[144:147], v[40:43]
    ds_read_b128 v[72:75], v18 offset:4096
    v_mfma_f32_16x16x32_bf16 v[44:47], v[116:119], v[148:151], v[44:47]
    ds_read_b128 v[76:79], v18 offset:6144
    buffer_load_dwordx4 v9, s[8:11], s39 offen offset:1024 lds
    v_mfma_f32_16x16x32_bf16 v[48:51], v[120:123], v[144:147], v[48:51]
    ds_read_b128 v[96:99], v16 offset:0
    v_mfma_f32_16x16x32_bf16 v[52:55], v[120:123], v[148:151], v[52:55]
    ds_read_b128 v[100:103], v16 offset:2048
    v_mfma_f32_16x16x32_bf16 v[56:59], v[124:127], v[144:147], v[56:59]
    ds_read_b128 v[80:83], v18 offset:1024
    buffer_load_dwordx4 v10, s[8:11], s39 offen offset:2048 lds
    v_mfma_f32_16x16x32_bf16 v[60:63], v[124:127], v[148:151], v[60:63]
    ds_read_b128 v[84:87], v18 offset:3072
    v_mfma_f32_16x16x32_bf16 v[32:35], v[128:131], v[152:155], v[32:35]
    ds_read_b128 v[88:91], v18 offset:5120
    buffer_load_dwordx4 v11, s[8:11], s39 offen offset:3072 lds
    v_mfma_f32_16x16x32_bf16 v[36:39], v[128:131], v[156:159], v[36:39]
    ds_read_b128 v[92:95], v18 offset:7168
    v_mfma_f32_16x16x32_bf16 v[40:43], v[132:135], v[152:155], v[40:43]
    ds_read_b128 v[104:107], v17 offset:0
    v_mfma_f32_16x16x32_bf16 v[44:47], v[132:135], v[156:159], v[44:47]
    ds_read_b128 v[108:111], v17 offset:2048
    s_add_u32 s40, s37, 122880
    s_mov_b32 m0, s40
    s_lshl_b32 s38, s41, 13
    buffer_load_dwordx4 v4, s[16:19], s38 offen lds
    v_mfma_f32_16x16x32_bf16 v[48:51], v[136:139], v[152:155], v[48:51]
    v_mfma_f32_16x16x32_bf16 v[52:55], v[136:139], v[156:159], v[52:55]
    buffer_load_dwordx4 v4, s[16:19], s38 offen offset:1024 lds
    v_mfma_f32_16x16x32_bf16 v[56:59], v[140:143], v[152:155], v[56:59]
    v_mfma_f32_16x16x32_bf16 v[60:63], v[140:143], v[156:159], v[60:63]
    s_waitcnt lgkmcnt(0)
    s_waitcnt vmcnt(24)
    s_barrier
    v_mfma_f32_16x16x32_bf16 v[32:35], v[64:67], v[96:99], v[32:35]
    ds_read_b128 v[112:115], v18 offset:24576
    v_mfma_f32_16x16x32_bf16 v[36:39], v[64:67], v[100:103], v[36:39]
    ds_read_b128 v[116:119], v18 offset:26624
    s_add_u32 s40, s36, 0
    s_mov_b32 m0, s40
    s_add_u32 s41, s42, 24
    s_and_b32 s41, s41, 31
    s_lshl_b32 s39, s41, 7
    buffer_load_dwordx4 v8, s[8:11], s39 offen lds
    v_mfma_f32_16x16x32_bf16 v[40:43], v[68:71], v[96:99], v[40:43]
    ds_read_b128 v[120:123], v18 offset:28672
    v_mfma_f32_16x16x32_bf16 v[44:47], v[68:71], v[100:103], v[44:47]
    ds_read_b128 v[124:127], v18 offset:30720
    buffer_load_dwordx4 v9, s[8:11], s39 offen offset:1024 lds
    v_mfma_f32_16x16x32_bf16 v[48:51], v[72:75], v[96:99], v[48:51]
    ds_read_b128 v[144:147], v16 offset:24576
    v_mfma_f32_16x16x32_bf16 v[52:55], v[72:75], v[100:103], v[52:55]
    ds_read_b128 v[148:151], v16 offset:26624
    v_mfma_f32_16x16x32_bf16 v[56:59], v[76:79], v[96:99], v[56:59]
    ds_read_b128 v[128:131], v18 offset:25600
    buffer_load_dwordx4 v10, s[8:11], s39 offen offset:2048 lds
    v_mfma_f32_16x16x32_bf16 v[60:63], v[76:79], v[100:103], v[60:63]
    ds_read_b128 v[132:135], v18 offset:27648
    v_mfma_f32_16x16x32_bf16 v[32:35], v[80:83], v[104:107], v[32:35]
    ds_read_b128 v[136:139], v18 offset:29696
    buffer_load_dwordx4 v11, s[8:11], s39 offen offset:3072 lds
    v_mfma_f32_16x16x32_bf16 v[36:39], v[80:83], v[108:111], v[36:39]
    ds_read_b128 v[140:143], v18 offset:31744
    v_mfma_f32_16x16x32_bf16 v[40:43], v[84:87], v[104:107], v[40:43]
    ds_read_b128 v[152:155], v17 offset:24576
    v_mfma_f32_16x16x32_bf16 v[44:47], v[84:87], v[108:111], v[44:47]
    ds_read_b128 v[156:159], v17 offset:26624
    s_add_u32 s40, s37, 0
    s_mov_b32 m0, s40
    s_lshl_b32 s38, s41, 13
    buffer_load_dwordx4 v4, s[16:19], s38 offen lds
    v_mfma_f32_16x16x32_bf16 v[48:51], v[88:91], v[104:107], v[48:51]
    v_mfma_f32_16x16x32_bf16 v[52:55], v[88:91], v[108:111], v[52:55]
    buffer_load_dwordx4 v4, s[16:19], s38 offen offset:1024 lds
    v_mfma_f32_16x16x32_bf16 v[56:59], v[92:95], v[104:107], v[56:59]
    v_mfma_f32_16x16x32_bf16 v[60:63], v[92:95], v[108:111], v[60:63]
    s_waitcnt lgkmcnt(0)
    s_waitcnt vmcnt(24)
    s_barrier
    v_mfma_f32_16x16x32_bf16 v[32:35], v[112:115], v[144:147], v[32:35]
    ds_read_b128 v[64:67], v21 offset:0
    v_mfma_f32_16x16x32_bf16 v[36:39], v[112:115], v[148:151], v[36:39]
    ds_read_b128 v[68:71], v21 offset:2048
    s_add_u32 s40, s36, 24576
    s_mov_b32 m0, s40
    s_add_u32 s41, s42, 25
    s_and_b32 s41, s41, 31
    s_lshl_b32 s39, s41, 7
    buffer_load_dwordx4 v8, s[8:11], s39 offen lds
    v_mfma_f32_16x16x32_bf16 v[40:43], v[116:119], v[144:147], v[40:43]
    ds_read_b128 v[72:75], v21 offset:4096
    v_mfma_f32_16x16x32_bf16 v[44:47], v[116:119], v[148:151], v[44:47]
    ds_read_b128 v[76:79], v21 offset:6144
    buffer_load_dwordx4 v9, s[8:11], s39 offen offset:1024 lds
    v_mfma_f32_16x16x32_bf16 v[48:51], v[120:123], v[144:147], v[48:51]
    ds_read_b128 v[96:99], v19 offset:0
    v_mfma_f32_16x16x32_bf16 v[52:55], v[120:123], v[148:151], v[52:55]
    ds_read_b128 v[100:103], v19 offset:2048
    v_mfma_f32_16x16x32_bf16 v[56:59], v[124:127], v[144:147], v[56:59]
    ds_read_b128 v[80:83], v21 offset:1024
    buffer_load_dwordx4 v10, s[8:11], s39 offen offset:2048 lds
    v_mfma_f32_16x16x32_bf16 v[60:63], v[124:127], v[148:151], v[60:63]
    ds_read_b128 v[84:87], v21 offset:3072
    v_mfma_f32_16x16x32_bf16 v[32:35], v[128:131], v[152:155], v[32:35]
    ds_read_b128 v[88:91], v21 offset:5120
    buffer_load_dwordx4 v11, s[8:11], s39 offen offset:3072 lds
    v_mfma_f32_16x16x32_bf16 v[36:39], v[128:131], v[156:159], v[36:39]
    ds_read_b128 v[92:95], v21 offset:7168
    v_mfma_f32_16x16x32_bf16 v[40:43], v[132:135], v[152:155], v[40:43]
    ds_read_b128 v[104:107], v20 offset:0
    v_mfma_f32_16x16x32_bf16 v[44:47], v[132:135], v[156:159], v[44:47]
    ds_read_b128 v[108:111], v20 offset:2048
    s_add_u32 s40, s37, 24576
    s_mov_b32 m0, s40
    s_lshl_b32 s38, s41, 13
    buffer_load_dwordx4 v4, s[16:19], s38 offen lds
    v_mfma_f32_16x16x32_bf16 v[48:51], v[136:139], v[152:155], v[48:51]
    v_mfma_f32_16x16x32_bf16 v[52:55], v[136:139], v[156:159], v[52:55]
    buffer_load_dwordx4 v4, s[16:19], s38 offen offset:1024 lds
    v_mfma_f32_16x16x32_bf16 v[56:59], v[140:143], v[152:155], v[56:59]
    v_mfma_f32_16x16x32_bf16 v[60:63], v[140:143], v[156:159], v[60:63]
    s_waitcnt lgkmcnt(0)
    s_waitcnt vmcnt(24)
    s_barrier
    v_mfma_f32_16x16x32_bf16 v[32:35], v[64:67], v[96:99], v[32:35]
    ds_read_b128 v[112:115], v21 offset:24576
    v_mfma_f32_16x16x32_bf16 v[36:39], v[64:67], v[100:103], v[36:39]
    ds_read_b128 v[116:119], v21 offset:26624
    s_add_u32 s40, s36, 49152
    s_mov_b32 m0, s40
    s_add_u32 s41, s42, 26
    s_and_b32 s41, s41, 31
    s_lshl_b32 s39, s41, 7
    buffer_load_dwordx4 v8, s[8:11], s39 offen lds
    v_mfma_f32_16x16x32_bf16 v[40:43], v[68:71], v[96:99], v[40:43]
    ds_read_b128 v[120:123], v21 offset:28672
    v_mfma_f32_16x16x32_bf16 v[44:47], v[68:71], v[100:103], v[44:47]
    ds_read_b128 v[124:127], v21 offset:30720
    buffer_load_dwordx4 v9, s[8:11], s39 offen offset:1024 lds
    v_mfma_f32_16x16x32_bf16 v[48:51], v[72:75], v[96:99], v[48:51]
    ds_read_b128 v[144:147], v19 offset:24576
    v_mfma_f32_16x16x32_bf16 v[52:55], v[72:75], v[100:103], v[52:55]
    ds_read_b128 v[148:151], v19 offset:26624
    v_mfma_f32_16x16x32_bf16 v[56:59], v[76:79], v[96:99], v[56:59]
    ds_read_b128 v[128:131], v21 offset:25600
    buffer_load_dwordx4 v10, s[8:11], s39 offen offset:2048 lds
    v_mfma_f32_16x16x32_bf16 v[60:63], v[76:79], v[100:103], v[60:63]
    ds_read_b128 v[132:135], v21 offset:27648
    v_mfma_f32_16x16x32_bf16 v[32:35], v[80:83], v[104:107], v[32:35]
    ds_read_b128 v[136:139], v21 offset:29696
    buffer_load_dwordx4 v11, s[8:11], s39 offen offset:3072 lds
    v_mfma_f32_16x16x32_bf16 v[36:39], v[80:83], v[108:111], v[36:39]
    ds_read_b128 v[140:143], v21 offset:31744
    v_mfma_f32_16x16x32_bf16 v[40:43], v[84:87], v[104:107], v[40:43]
    ds_read_b128 v[152:155], v20 offset:24576
    v_mfma_f32_16x16x32_bf16 v[44:47], v[84:87], v[108:111], v[44:47]
    ds_read_b128 v[156:159], v20 offset:26624
    s_add_u32 s40, s37, 49152
    s_mov_b32 m0, s40
    s_lshl_b32 s38, s41, 13
    buffer_load_dwordx4 v4, s[16:19], s38 offen lds
    v_mfma_f32_16x16x32_bf16 v[48:51], v[88:91], v[104:107], v[48:51]
    v_mfma_f32_16x16x32_bf16 v[52:55], v[88:91], v[108:111], v[52:55]
    buffer_load_dwordx4 v4, s[16:19], s38 offen offset:1024 lds
    v_mfma_f32_16x16x32_bf16 v[56:59], v[92:95], v[104:107], v[56:59]
    v_mfma_f32_16x16x32_bf16 v[60:63], v[92:95], v[108:111], v[60:63]
    s_waitcnt lgkmcnt(0)
    s_waitcnt vmcnt(24)
    s_barrier
    v_mfma_f32_16x16x32_bf16 v[32:35], v[112:115], v[144:147], v[32:35]
    ds_read_b128 v[64:67], v24 offset:0
    v_mfma_f32_16x16x32_bf16 v[36:39], v[112:115], v[148:151], v[36:39]
    ds_read_b128 v[68:71], v24 offset:2048
    s_add_u32 s40, s36, 73728
    s_mov_b32 m0, s40
    s_add_u32 s41, s42, 27
    s_and_b32 s41, s41, 31
    s_lshl_b32 s39, s41, 7
    buffer_load_dwordx4 v8, s[8:11], s39 offen lds
    v_mfma_f32_16x16x32_bf16 v[40:43], v[116:119], v[144:147], v[40:43]
    ds_read_b128 v[72:75], v24 offset:4096
    v_mfma_f32_16x16x32_bf16 v[44:47], v[116:119], v[148:151], v[44:47]
    ds_read_b128 v[76:79], v24 offset:6144
    buffer_load_dwordx4 v9, s[8:11], s39 offen offset:1024 lds
    v_mfma_f32_16x16x32_bf16 v[48:51], v[120:123], v[144:147], v[48:51]
    ds_read_b128 v[96:99], v22 offset:0
    v_mfma_f32_16x16x32_bf16 v[52:55], v[120:123], v[148:151], v[52:55]
    ds_read_b128 v[100:103], v22 offset:2048
    v_mfma_f32_16x16x32_bf16 v[56:59], v[124:127], v[144:147], v[56:59]
    ds_read_b128 v[80:83], v24 offset:1024
    buffer_load_dwordx4 v10, s[8:11], s39 offen offset:2048 lds
    v_mfma_f32_16x16x32_bf16 v[60:63], v[124:127], v[148:151], v[60:63]
    ds_read_b128 v[84:87], v24 offset:3072
    v_mfma_f32_16x16x32_bf16 v[32:35], v[128:131], v[152:155], v[32:35]
    ds_read_b128 v[88:91], v24 offset:5120
    buffer_load_dwordx4 v11, s[8:11], s39 offen offset:3072 lds
    v_mfma_f32_16x16x32_bf16 v[36:39], v[128:131], v[156:159], v[36:39]
    ds_read_b128 v[92:95], v24 offset:7168
    v_mfma_f32_16x16x32_bf16 v[40:43], v[132:135], v[152:155], v[40:43]
    ds_read_b128 v[104:107], v23 offset:0
    v_mfma_f32_16x16x32_bf16 v[44:47], v[132:135], v[156:159], v[44:47]
    ds_read_b128 v[108:111], v23 offset:2048
    s_add_u32 s40, s37, 73728
    s_mov_b32 m0, s40
    s_lshl_b32 s38, s41, 13
    buffer_load_dwordx4 v4, s[16:19], s38 offen lds
    v_mfma_f32_16x16x32_bf16 v[48:51], v[136:139], v[152:155], v[48:51]
    v_mfma_f32_16x16x32_bf16 v[52:55], v[136:139], v[156:159], v[52:55]
    buffer_load_dwordx4 v4, s[16:19], s38 offen offset:1024 lds
    v_mfma_f32_16x16x32_bf16 v[56:59], v[140:143], v[152:155], v[56:59]
    v_mfma_f32_16x16x32_bf16 v[60:63], v[140:143], v[156:159], v[60:63]
    s_waitcnt lgkmcnt(0)
    s_waitcnt vmcnt(24)
    s_barrier
    v_mfma_f32_16x16x32_bf16 v[32:35], v[64:67], v[96:99], v[32:35]
    ds_read_b128 v[112:115], v24 offset:24576
    v_mfma_f32_16x16x32_bf16 v[36:39], v[64:67], v[100:103], v[36:39]
    ds_read_b128 v[116:119], v24 offset:26624
    s_add_u32 s40, s36, 98304
    s_mov_b32 m0, s40
    s_add_u32 s41, s42, 28
    s_and_b32 s41, s41, 31
    s_lshl_b32 s39, s41, 7
    buffer_load_dwordx4 v8, s[8:11], s39 offen lds
    v_mfma_f32_16x16x32_bf16 v[40:43], v[68:71], v[96:99], v[40:43]
    ds_read_b128 v[120:123], v24 offset:28672
    v_mfma_f32_16x16x32_bf16 v[44:47], v[68:71], v[100:103], v[44:47]
    ds_read_b128 v[124:127], v24 offset:30720
    buffer_load_dwordx4 v9, s[8:11], s39 offen offset:1024 lds
    v_mfma_f32_16x16x32_bf16 v[48:51], v[72:75], v[96:99], v[48:51]
    ds_read_b128 v[144:147], v22 offset:24576
    v_mfma_f32_16x16x32_bf16 v[52:55], v[72:75], v[100:103], v[52:55]
    ds_read_b128 v[148:151], v22 offset:26624
    v_mfma_f32_16x16x32_bf16 v[56:59], v[76:79], v[96:99], v[56:59]
    ds_read_b128 v[128:131], v24 offset:25600
    buffer_load_dwordx4 v10, s[8:11], s39 offen offset:2048 lds
    v_mfma_f32_16x16x32_bf16 v[60:63], v[76:79], v[100:103], v[60:63]
    ds_read_b128 v[132:135], v24 offset:27648
    v_mfma_f32_16x16x32_bf16 v[32:35], v[80:83], v[104:107], v[32:35]
    ds_read_b128 v[136:139], v24 offset:29696
    buffer_load_dwordx4 v11, s[8:11], s39 offen offset:3072 lds
    v_mfma_f32_16x16x32_bf16 v[36:39], v[80:83], v[108:111], v[36:39]
    ds_read_b128 v[140:143], v24 offset:31744
    v_mfma_f32_16x16x32_bf16 v[40:43], v[84:87], v[104:107], v[40:43]
    ds_read_b128 v[152:155], v23 offset:24576
    v_mfma_f32_16x16x32_bf16 v[44:47], v[84:87], v[108:111], v[44:47]
    ds_read_b128 v[156:159], v23 offset:26624
    s_add_u32 s40, s37, 98304
    s_mov_b32 m0, s40
    s_lshl_b32 s38, s41, 13
    buffer_load_dwordx4 v4, s[16:19], s38 offen lds
    v_mfma_f32_16x16x32_bf16 v[48:51], v[88:91], v[104:107], v[48:51]
    v_mfma_f32_16x16x32_bf16 v[52:55], v[88:91], v[108:111], v[52:55]
    buffer_load_dwordx4 v4, s[16:19], s38 offen offset:1024 lds
    v_mfma_f32_16x16x32_bf16 v[56:59], v[92:95], v[104:107], v[56:59]
    v_mfma_f32_16x16x32_bf16 v[60:63], v[92:95], v[108:111], v[60:63]
    s_waitcnt lgkmcnt(0)
    s_waitcnt vmcnt(24)
    s_barrier
    v_mfma_f32_16x16x32_bf16 v[32:35], v[112:115], v[144:147], v[32:35]
    ds_read_b128 v[64:67], v18 offset:0
    v_mfma_f32_16x16x32_bf16 v[36:39], v[112:115], v[148:151], v[36:39]
    ds_read_b128 v[68:71], v18 offset:2048
    s_add_u32 s40, s36, 122880
    s_mov_b32 m0, s40
    s_add_u32 s41, s42, 29
    s_and_b32 s41, s41, 31
    s_lshl_b32 s39, s41, 7
    buffer_load_dwordx4 v8, s[8:11], s39 offen lds
    v_mfma_f32_16x16x32_bf16 v[40:43], v[116:119], v[144:147], v[40:43]
    ds_read_b128 v[72:75], v18 offset:4096
    v_mfma_f32_16x16x32_bf16 v[44:47], v[116:119], v[148:151], v[44:47]
    ds_read_b128 v[76:79], v18 offset:6144
    buffer_load_dwordx4 v9, s[8:11], s39 offen offset:1024 lds
    v_mfma_f32_16x16x32_bf16 v[48:51], v[120:123], v[144:147], v[48:51]
    ds_read_b128 v[96:99], v16 offset:0
    v_mfma_f32_16x16x32_bf16 v[52:55], v[120:123], v[148:151], v[52:55]
    ds_read_b128 v[100:103], v16 offset:2048
    v_mfma_f32_16x16x32_bf16 v[56:59], v[124:127], v[144:147], v[56:59]
    ds_read_b128 v[80:83], v18 offset:1024
    buffer_load_dwordx4 v10, s[8:11], s39 offen offset:2048 lds
    v_mfma_f32_16x16x32_bf16 v[60:63], v[124:127], v[148:151], v[60:63]
    ds_read_b128 v[84:87], v18 offset:3072
    v_mfma_f32_16x16x32_bf16 v[32:35], v[128:131], v[152:155], v[32:35]
    ds_read_b128 v[88:91], v18 offset:5120
    buffer_load_dwordx4 v11, s[8:11], s39 offen offset:3072 lds
    v_mfma_f32_16x16x32_bf16 v[36:39], v[128:131], v[156:159], v[36:39]
    ds_read_b128 v[92:95], v18 offset:7168
    v_mfma_f32_16x16x32_bf16 v[40:43], v[132:135], v[152:155], v[40:43]
    ds_read_b128 v[104:107], v17 offset:0
    v_mfma_f32_16x16x32_bf16 v[44:47], v[132:135], v[156:159], v[44:47]
    ds_read_b128 v[108:111], v17 offset:2048
    s_add_u32 s40, s37, 122880
    s_mov_b32 m0, s40
    s_lshl_b32 s38, s41, 13
    buffer_load_dwordx4 v4, s[16:19], s38 offen lds
    v_mfma_f32_16x16x32_bf16 v[48:51], v[136:139], v[152:155], v[48:51]
    v_mfma_f32_16x16x32_bf16 v[52:55], v[136:139], v[156:159], v[52:55]
    buffer_load_dwordx4 v4, s[16:19], s38 offen offset:1024 lds
    v_mfma_f32_16x16x32_bf16 v[56:59], v[140:143], v[152:155], v[56:59]
    v_mfma_f32_16x16x32_bf16 v[60:63], v[140:143], v[156:159], v[60:63]
    s_waitcnt lgkmcnt(0)
    s_waitcnt vmcnt(24)
    s_barrier
    v_mfma_f32_16x16x32_bf16 v[32:35], v[64:67], v[96:99], v[32:35]
    ds_read_b128 v[112:115], v18 offset:24576
    v_mfma_f32_16x16x32_bf16 v[36:39], v[64:67], v[100:103], v[36:39]
    ds_read_b128 v[116:119], v18 offset:26624
    s_add_u32 s40, s36, 0
    s_mov_b32 m0, s40
    s_add_u32 s41, s42, 30
    s_and_b32 s41, s41, 31
    s_lshl_b32 s39, s41, 7
    buffer_load_dwordx4 v8, s[8:11], s39 offen lds
    v_mfma_f32_16x16x32_bf16 v[40:43], v[68:71], v[96:99], v[40:43]
    ds_read_b128 v[120:123], v18 offset:28672
    v_mfma_f32_16x16x32_bf16 v[44:47], v[68:71], v[100:103], v[44:47]
    ds_read_b128 v[124:127], v18 offset:30720
    buffer_load_dwordx4 v9, s[8:11], s39 offen offset:1024 lds
    v_mfma_f32_16x16x32_bf16 v[48:51], v[72:75], v[96:99], v[48:51]
    ds_read_b128 v[144:147], v16 offset:24576
    v_mfma_f32_16x16x32_bf16 v[52:55], v[72:75], v[100:103], v[52:55]
    ds_read_b128 v[148:151], v16 offset:26624
    v_mfma_f32_16x16x32_bf16 v[56:59], v[76:79], v[96:99], v[56:59]
    ds_read_b128 v[128:131], v18 offset:25600
    buffer_load_dwordx4 v10, s[8:11], s39 offen offset:2048 lds
    v_mfma_f32_16x16x32_bf16 v[60:63], v[76:79], v[100:103], v[60:63]
    ds_read_b128 v[132:135], v18 offset:27648
    v_mfma_f32_16x16x32_bf16 v[32:35], v[80:83], v[104:107], v[32:35]
    ds_read_b128 v[136:139], v18 offset:29696
    buffer_load_dwordx4 v11, s[8:11], s39 offen offset:3072 lds
    v_mfma_f32_16x16x32_bf16 v[36:39], v[80:83], v[108:111], v[36:39]
    ds_read_b128 v[140:143], v18 offset:31744
    v_mfma_f32_16x16x32_bf16 v[40:43], v[84:87], v[104:107], v[40:43]
    ds_read_b128 v[152:155], v17 offset:24576
    v_mfma_f32_16x16x32_bf16 v[44:47], v[84:87], v[108:111], v[44:47]
    ds_read_b128 v[156:159], v17 offset:26624
    s_add_u32 s40, s37, 0
    s_mov_b32 m0, s40
    s_lshl_b32 s38, s41, 13
    buffer_load_dwordx4 v4, s[16:19], s38 offen lds
    v_mfma_f32_16x16x32_bf16 v[48:51], v[88:91], v[104:107], v[48:51]
    v_mfma_f32_16x16x32_bf16 v[52:55], v[88:91], v[108:111], v[52:55]
    buffer_load_dwordx4 v4, s[16:19], s38 offen offset:1024 lds
    v_mfma_f32_16x16x32_bf16 v[56:59], v[92:95], v[104:107], v[56:59]
    v_mfma_f32_16x16x32_bf16 v[60:63], v[92:95], v[108:111], v[60:63]
    s_waitcnt lgkmcnt(0)
    s_waitcnt vmcnt(24)
    s_barrier
    v_mfma_f32_16x16x32_bf16 v[32:35], v[112:115], v[144:147], v[32:35]
    ds_read_b128 v[64:67], v21 offset:0
    v_mfma_f32_16x16x32_bf16 v[36:39], v[112:115], v[148:151], v[36:39]
    ds_read_b128 v[68:71], v21 offset:2048
    s_add_u32 s40, s36, 24576
    s_mov_b32 m0, s40
    s_add_u32 s41, s42, 31
    s_and_b32 s41, s41, 31
    s_lshl_b32 s39, s41, 7
    buffer_load_dwordx4 v8, s[8:11], s39 offen lds
    v_mfma_f32_16x16x32_bf16 v[40:43], v[116:119], v[144:147], v[40:43]
    ds_read_b128 v[72:75], v21 offset:4096
    v_mfma_f32_16x16x32_bf16 v[44:47], v[116:119], v[148:151], v[44:47]
    ds_read_b128 v[76:79], v21 offset:6144
    buffer_load_dwordx4 v9, s[8:11], s39 offen offset:1024 lds
    v_mfma_f32_16x16x32_bf16 v[48:51], v[120:123], v[144:147], v[48:51]
    ds_read_b128 v[96:99], v19 offset:0
    v_mfma_f32_16x16x32_bf16 v[52:55], v[120:123], v[148:151], v[52:55]
    ds_read_b128 v[100:103], v19 offset:2048
    v_mfma_f32_16x16x32_bf16 v[56:59], v[124:127], v[144:147], v[56:59]
    ds_read_b128 v[80:83], v21 offset:1024
    buffer_load_dwordx4 v10, s[8:11], s39 offen offset:2048 lds
    v_mfma_f32_16x16x32_bf16 v[60:63], v[124:127], v[148:151], v[60:63]
    ds_read_b128 v[84:87], v21 offset:3072
    v_mfma_f32_16x16x32_bf16 v[32:35], v[128:131], v[152:155], v[32:35]
    ds_read_b128 v[88:91], v21 offset:5120
    buffer_load_dwordx4 v11, s[8:11], s39 offen offset:3072 lds
    v_mfma_f32_16x16x32_bf16 v[36:39], v[128:131], v[156:159], v[36:39]
    ds_read_b128 v[92:95], v21 offset:7168
    v_mfma_f32_16x16x32_bf16 v[40:43], v[132:135], v[152:155], v[40:43]
    ds_read_b128 v[104:107], v20 offset:0
    v_mfma_f32_16x16x32_bf16 v[44:47], v[132:135], v[156:159], v[44:47]
    ds_read_b128 v[108:111], v20 offset:2048
    s_add_u32 s40, s37, 24576
    s_mov_b32 m0, s40
    s_lshl_b32 s38, s41, 13
    buffer_load_dwordx4 v4, s[16:19], s38 offen lds
    v_mfma_f32_16x16x32_bf16 v[48:51], v[136:139], v[152:155], v[48:51]
    v_mfma_f32_16x16x32_bf16 v[52:55], v[136:139], v[156:159], v[52:55]
    buffer_load_dwordx4 v4, s[16:19], s38 offen offset:1024 lds
    v_mfma_f32_16x16x32_bf16 v[56:59], v[140:143], v[152:155], v[56:59]
    v_mfma_f32_16x16x32_bf16 v[60:63], v[140:143], v[156:159], v[60:63]
    s_waitcnt lgkmcnt(0)
    s_waitcnt vmcnt(24)
    s_barrier
    buffer_load_dword v29, v30, s[52:55], 0 offen
    v_mfma_f32_16x16x32_bf16 v[32:35], v[64:67], v[96:99], v[32:35]
    ds_read_b128 v[112:115], v21 offset:24576
    v_mfma_f32_16x16x32_bf16 v[36:39], v[64:67], v[100:103], v[36:39]
    ds_read_b128 v[116:119], v21 offset:26624
    v_mfma_f32_16x16x32_bf16 v[40:43], v[68:71], v[96:99], v[40:43]
    ds_read_b128 v[120:123], v21 offset:28672
    v_mfma_f32_16x16x32_bf16 v[44:47], v[68:71], v[100:103], v[44:47]
    ds_read_b128 v[124:127], v21 offset:30720
    v_mfma_f32_16x16x32_bf16 v[48:51], v[72:75], v[96:99], v[48:51]
    ds_read_b128 v[144:147], v19 offset:24576
    v_mfma_f32_16x16x32_bf16 v[52:55], v[72:75], v[100:103], v[52:55]
    ds_read_b128 v[148:151], v19 offset:26624
    v_mfma_f32_16x16x32_bf16 v[56:59], v[76:79], v[96:99], v[56:59]
    ds_read_b128 v[128:131], v21 offset:25600
    v_mfma_f32_16x16x32_bf16 v[60:63], v[76:79], v[100:103], v[60:63]
    ds_read_b128 v[132:135], v21 offset:27648
    v_mfma_f32_16x16x32_bf16 v[32:35], v[80:83], v[104:107], v[32:35]
    ds_read_b128 v[136:139], v21 offset:29696
    v_mfma_f32_16x16x32_bf16 v[36:39], v[80:83], v[108:111], v[36:39]
    ds_read_b128 v[140:143], v21 offset:31744
    v_mfma_f32_16x16x32_bf16 v[40:43], v[84:87], v[104:107], v[40:43]
    ds_read_b128 v[152:155], v20 offset:24576
    v_mfma_f32_16x16x32_bf16 v[44:47], v[84:87], v[108:111], v[44:47]
    ds_read_b128 v[156:159], v20 offset:26624
    v_mfma_f32_16x16x32_bf16 v[48:51], v[88:91], v[104:107], v[48:51]
    v_mfma_f32_16x16x32_bf16 v[52:55], v[88:91], v[108:111], v[52:55]
    v_mfma_f32_16x16x32_bf16 v[56:59], v[92:95], v[104:107], v[56:59]
    v_mfma_f32_16x16x32_bf16 v[60:63], v[92:95], v[108:111], v[60:63]
    s_waitcnt lgkmcnt(0)
    s_waitcnt vmcnt(19)
    s_barrier
    v_mfma_f32_16x16x32_bf16 v[32:35], v[112:115], v[144:147], v[32:35]
    ds_read_b128 v[64:67], v24 offset:0
    v_mfma_f32_16x16x32_bf16 v[36:39], v[112:115], v[148:151], v[36:39]
    ds_read_b128 v[68:71], v24 offset:2048
    v_mfma_f32_16x16x32_bf16 v[40:43], v[116:119], v[144:147], v[40:43]
    ds_read_b128 v[72:75], v24 offset:4096
    v_mfma_f32_16x16x32_bf16 v[44:47], v[116:119], v[148:151], v[44:47]
    ds_read_b128 v[76:79], v24 offset:6144
    v_mfma_f32_16x16x32_bf16 v[48:51], v[120:123], v[144:147], v[48:51]
    ds_read_b128 v[96:99], v22 offset:0
    v_mfma_f32_16x16x32_bf16 v[52:55], v[120:123], v[148:151], v[52:55]
    ds_read_b128 v[100:103], v22 offset:2048
    v_mfma_f32_16x16x32_bf16 v[56:59], v[124:127], v[144:147], v[56:59]
    ds_read_b128 v[80:83], v24 offset:1024
    v_mfma_f32_16x16x32_bf16 v[60:63], v[124:127], v[148:151], v[60:63]
    ds_read_b128 v[84:87], v24 offset:3072
    v_mfma_f32_16x16x32_bf16 v[32:35], v[128:131], v[152:155], v[32:35]
    ds_read_b128 v[88:91], v24 offset:5120
    v_mfma_f32_16x16x32_bf16 v[36:39], v[128:131], v[156:159], v[36:39]
    ds_read_b128 v[92:95], v24 offset:7168
    v_mfma_f32_16x16x32_bf16 v[40:43], v[132:135], v[152:155], v[40:43]
    ds_read_b128 v[104:107], v23 offset:0
    v_mfma_f32_16x16x32_bf16 v[44:47], v[132:135], v[156:159], v[44:47]
    ds_read_b128 v[108:111], v23 offset:2048
    v_mfma_f32_16x16x32_bf16 v[48:51], v[136:139], v[152:155], v[48:51]
    v_mfma_f32_16x16x32_bf16 v[52:55], v[136:139], v[156:159], v[52:55]
    v_mfma_f32_16x16x32_bf16 v[56:59], v[140:143], v[152:155], v[56:59]
    v_mfma_f32_16x16x32_bf16 v[60:63], v[140:143], v[156:159], v[60:63]
    s_waitcnt lgkmcnt(0)
    s_waitcnt vmcnt(13)
    s_barrier
    v_mfma_f32_16x16x32_bf16 v[32:35], v[64:67], v[96:99], v[32:35]
    ds_read_b128 v[112:115], v24 offset:24576
    v_mfma_f32_16x16x32_bf16 v[36:39], v[64:67], v[100:103], v[36:39]
    ds_read_b128 v[116:119], v24 offset:26624
    v_mfma_f32_16x16x32_bf16 v[40:43], v[68:71], v[96:99], v[40:43]
    ds_read_b128 v[120:123], v24 offset:28672
    v_mfma_f32_16x16x32_bf16 v[44:47], v[68:71], v[100:103], v[44:47]
    ds_read_b128 v[124:127], v24 offset:30720
    v_mfma_f32_16x16x32_bf16 v[48:51], v[72:75], v[96:99], v[48:51]
    ds_read_b128 v[144:147], v22 offset:24576
    v_mfma_f32_16x16x32_bf16 v[52:55], v[72:75], v[100:103], v[52:55]
    ds_read_b128 v[148:151], v22 offset:26624
    v_mfma_f32_16x16x32_bf16 v[56:59], v[76:79], v[96:99], v[56:59]
    ds_read_b128 v[128:131], v24 offset:25600
    v_mfma_f32_16x16x32_bf16 v[60:63], v[76:79], v[100:103], v[60:63]
    ds_read_b128 v[132:135], v24 offset:27648
    v_mfma_f32_16x16x32_bf16 v[32:35], v[80:83], v[104:107], v[32:35]
    ds_read_b128 v[136:139], v24 offset:29696
    v_mfma_f32_16x16x32_bf16 v[36:39], v[80:83], v[108:111], v[36:39]
    ds_read_b128 v[140:143], v24 offset:31744
    v_mfma_f32_16x16x32_bf16 v[40:43], v[84:87], v[104:107], v[40:43]
    ds_read_b128 v[152:155], v23 offset:24576
    v_mfma_f32_16x16x32_bf16 v[44:47], v[84:87], v[108:111], v[44:47]
    ds_read_b128 v[156:159], v23 offset:26624
    v_mfma_f32_16x16x32_bf16 v[48:51], v[88:91], v[104:107], v[48:51]
    v_mfma_f32_16x16x32_bf16 v[52:55], v[88:91], v[108:111], v[52:55]
    v_mfma_f32_16x16x32_bf16 v[56:59], v[92:95], v[104:107], v[56:59]
    v_mfma_f32_16x16x32_bf16 v[60:63], v[92:95], v[108:111], v[60:63]
    s_waitcnt lgkmcnt(0)
    s_waitcnt vmcnt(7)
    s_barrier
    v_mfma_f32_16x16x32_bf16 v[32:35], v[112:115], v[144:147], v[32:35]
    ds_read_b128 v[64:67], v18 offset:0
    v_mfma_f32_16x16x32_bf16 v[36:39], v[112:115], v[148:151], v[36:39]
    ds_read_b128 v[68:71], v18 offset:2048
    v_mfma_f32_16x16x32_bf16 v[40:43], v[116:119], v[144:147], v[40:43]
    ds_read_b128 v[72:75], v18 offset:4096
    v_mfma_f32_16x16x32_bf16 v[44:47], v[116:119], v[148:151], v[44:47]
    ds_read_b128 v[76:79], v18 offset:6144
    v_mfma_f32_16x16x32_bf16 v[48:51], v[120:123], v[144:147], v[48:51]
    ds_read_b128 v[96:99], v16 offset:0
    v_mfma_f32_16x16x32_bf16 v[52:55], v[120:123], v[148:151], v[52:55]
    ds_read_b128 v[100:103], v16 offset:2048
    v_mfma_f32_16x16x32_bf16 v[56:59], v[124:127], v[144:147], v[56:59]
    ds_read_b128 v[80:83], v18 offset:1024
    v_mfma_f32_16x16x32_bf16 v[60:63], v[124:127], v[148:151], v[60:63]
    ds_read_b128 v[84:87], v18 offset:3072
    v_mfma_f32_16x16x32_bf16 v[32:35], v[128:131], v[152:155], v[32:35]
    ds_read_b128 v[88:91], v18 offset:5120
    v_mfma_f32_16x16x32_bf16 v[36:39], v[128:131], v[156:159], v[36:39]
    ds_read_b128 v[92:95], v18 offset:7168
    v_mfma_f32_16x16x32_bf16 v[40:43], v[132:135], v[152:155], v[40:43]
    ds_read_b128 v[104:107], v17 offset:0
    v_mfma_f32_16x16x32_bf16 v[44:47], v[132:135], v[156:159], v[44:47]
    ds_read_b128 v[108:111], v17 offset:2048
    v_mfma_f32_16x16x32_bf16 v[48:51], v[136:139], v[152:155], v[48:51]
    v_mfma_f32_16x16x32_bf16 v[52:55], v[136:139], v[156:159], v[52:55]
    v_mfma_f32_16x16x32_bf16 v[56:59], v[140:143], v[152:155], v[56:59]
    v_mfma_f32_16x16x32_bf16 v[60:63], v[140:143], v[156:159], v[60:63]
    s_waitcnt lgkmcnt(0)
    s_waitcnt vmcnt(1)
    s_barrier
    v_mfma_f32_16x16x32_bf16 v[32:35], v[64:67], v[96:99], v[32:35]
    ds_read_b128 v[112:115], v18 offset:24576
    v_mfma_f32_16x16x32_bf16 v[36:39], v[64:67], v[100:103], v[36:39]
    ds_read_b128 v[116:119], v18 offset:26624
    v_mfma_f32_16x16x32_bf16 v[40:43], v[68:71], v[96:99], v[40:43]
    ds_read_b128 v[120:123], v18 offset:28672
    v_mfma_f32_16x16x32_bf16 v[44:47], v[68:71], v[100:103], v[44:47]
    ds_read_b128 v[124:127], v18 offset:30720
    v_mfma_f32_16x16x32_bf16 v[48:51], v[72:75], v[96:99], v[48:51]
    ds_read_b128 v[144:147], v16 offset:24576
    v_mfma_f32_16x16x32_bf16 v[52:55], v[72:75], v[100:103], v[52:55]
    ds_read_b128 v[148:151], v16 offset:26624
    v_mfma_f32_16x16x32_bf16 v[56:59], v[76:79], v[96:99], v[56:59]
    ds_read_b128 v[128:131], v18 offset:25600
    v_mfma_f32_16x16x32_bf16 v[60:63], v[76:79], v[100:103], v[60:63]
    ds_read_b128 v[132:135], v18 offset:27648
    v_mfma_f32_16x16x32_bf16 v[32:35], v[80:83], v[104:107], v[32:35]
    ds_read_b128 v[136:139], v18 offset:29696
    v_mfma_f32_16x16x32_bf16 v[36:39], v[80:83], v[108:111], v[36:39]
    ds_read_b128 v[140:143], v18 offset:31744
    v_mfma_f32_16x16x32_bf16 v[40:43], v[84:87], v[104:107], v[40:43]
    ds_read_b128 v[152:155], v17 offset:24576
    v_mfma_f32_16x16x32_bf16 v[44:47], v[84:87], v[108:111], v[44:47]
    ds_read_b128 v[156:159], v17 offset:26624
    v_mfma_f32_16x16x32_bf16 v[48:51], v[88:91], v[104:107], v[48:51]
    v_mfma_f32_16x16x32_bf16 v[52:55], v[88:91], v[108:111], v[52:55]
    v_mfma_f32_16x16x32_bf16 v[56:59], v[92:95], v[104:107], v[56:59]
    v_mfma_f32_16x16x32_bf16 v[60:63], v[92:95], v[108:111], v[60:63]
    s_waitcnt lgkmcnt(0)
    v_mfma_f32_16x16x32_bf16 v[32:35], v[112:115], v[144:147], v[32:35]
    v_mfma_f32_16x16x32_bf16 v[36:39], v[112:115], v[148:151], v[36:39]
    v_mfma_f32_16x16x32_bf16 v[40:43], v[116:119], v[144:147], v[40:43]
    v_mfma_f32_16x16x32_bf16 v[44:47], v[116:119], v[148:151], v[44:47]
    v_mfma_f32_16x16x32_bf16 v[48:51], v[120:123], v[144:147], v[48:51]
    v_mfma_f32_16x16x32_bf16 v[52:55], v[120:123], v[148:151], v[52:55]
    v_mfma_f32_16x16x32_bf16 v[56:59], v[124:127], v[144:147], v[56:59]
    v_mfma_f32_16x16x32_bf16 v[60:63], v[124:127], v[148:151], v[60:63]
    v_mfma_f32_16x16x32_bf16 v[32:35], v[128:131], v[152:155], v[32:35]
    v_mfma_f32_16x16x32_bf16 v[36:39], v[128:131], v[156:159], v[36:39]
    v_mfma_f32_16x16x32_bf16 v[40:43], v[132:135], v[152:155], v[40:43]
    v_mfma_f32_16x16x32_bf16 v[44:47], v[132:135], v[156:159], v[44:47]
    v_mfma_f32_16x16x32_bf16 v[48:51], v[136:139], v[152:155], v[48:51]
    v_mfma_f32_16x16x32_bf16 v[52:55], v[136:139], v[156:159], v[52:55]
    v_mfma_f32_16x16x32_bf16 v[56:59], v[140:143], v[152:155], v[56:59]
    v_mfma_f32_16x16x32_bf16 v[60:63], v[140:143], v[156:159], v[60:63]
    s_nop 7
    s_nop 1
    v_cvt_pk_bf16_f32 v64, v32, v33
    v_cvt_pk_bf16_f32 v65, v34, v35
    v_cvt_pk_bf16_f32 v66, v40, v41
    v_cvt_pk_bf16_f32 v67, v42, v43
    buffer_store_dwordx4 v[64:67], v6, s[20:23], 0 offen offset:0
    v_cvt_pk_bf16_f32 v68, v48, v49
    v_cvt_pk_bf16_f32 v69, v50, v51
    v_cvt_pk_bf16_f32 v70, v56, v57
    v_cvt_pk_bf16_f32 v71, v58, v59
    buffer_store_dwordx4 v[68:71], v6, s[20:23], 0 offen offset:64
    v_cvt_pk_bf16_f32 v72, v36, v37
    v_cvt_pk_bf16_f32 v73, v38, v39
    v_cvt_pk_bf16_f32 v74, v44, v45
    v_cvt_pk_bf16_f32 v75, v46, v47
    buffer_store_dwordx4 v[72:75], v7, s[20:23], 0 offen offset:0
    v_cvt_pk_bf16_f32 v76, v52, v53
    v_cvt_pk_bf16_f32 v77, v54, v55
    v_cvt_pk_bf16_f32 v78, v60, v61
    v_cvt_pk_bf16_f32 v79, v62, v63
    buffer_store_dwordx4 v[76:79], v7, s[20:23], 0 offen offset:64
L_k2_end:
    s_endpgm
.globl k3_tail_kernel
.p2align 8
.type k3_tail_kernel,@function
k3_tail_kernel:
    s_cmp_ge_u32 s2, 256
    s_cbranch_scc1 L_k3_end
    s_load_dwordx2 s[4:5], s[0:1], 0
    s_load_dwordx8 s[40:47], s[0:1], 48
    s_load_dwordx2 s[8:9], s[0:1], 80
    s_load_dwordx2 s[12:13], s[0:1], 96
    v_and_b32 v1, 63, v0
    v_lshrrev_b32 v2, 6, v0
    s_nop 0
    v_readfirstlane_b32 s33, v2
    v_lshlrev_b32 v3, 4, v1
    s_mov_b32 s32, 0x200000
    s_waitcnt lgkmcnt(0)
    s_mov_b32 s16, s4
    s_and_b32 s17, s5, 0xffff
    s_mov_b32 s18, 0x200000
    s_mov_b32 s19, 0x00020000
    s_mov_b32 s20, s40
    s_and_b32 s21, s41, 0xffff
    s_mov_b32 s22, 0x400
    s_mov_b32 s23, 0x00020000
    s_mov_b32 s24, s8
    s_and_b32 s25, s9, 0xffff
    s_mov_b32 s26, 0x200000
    s_mov_b32 s27, 0x00020000
    s_add_u32 s28, s12, 0x400000
    s_addc_u32 s29, s13, 0
    s_and_b32 s29, s29, 0xffff
    s_mov_b32 s30, 0x700000
    s_mov_b32 s31, 0x00020000
    s_lshl_b32 s3, s2, 3
    s_add_u32 s3, s3, s33
    s_lshl_b32 s34, s3, 10
    v_add_u32 v4, s34, v3
    buffer_load_dwordx4 v[8:11], v4, s[28:31], 0 offen
    buffer_load_dwordx4 v[12:15], v4, s[28:31], s32 offen
    buffer_load_dwordx4 v[16:19], v4, s[16:19], 0 offen
    buffer_load_dwordx4 v[20:23], v3, s[20:23], 0 offen
    s_waitcnt vmcnt(2)
    v_lshlrev_b32 v24, 16, v8
    v_and_b32 v25, 0xffff0000, v8
    v_lshlrev_b32 v26, 16, v9
    v_and_b32 v27, 0xffff0000, v9
    v_lshlrev_b32 v28, 16, v10
    v_and_b32 v29, 0xffff0000, v10
    v_lshlrev_b32 v30, 16, v11
    v_and_b32 v31, 0xffff0000, v11
    v_lshlrev_b32 v32, 16, v12
    v_and_b32 v33, 0xffff0000, v12
    v_lshlrev_b32 v34, 16, v13
    v_and_b32 v35, 0xffff0000, v13
    v_lshlrev_b32 v36, 16, v14
    v_and_b32 v37, 0xffff0000, v14
    v_lshlrev_b32 v38, 16, v15
    v_and_b32 v39, 0xffff0000, v15
    v_sub_f32 v24, v24, v32
    v_sub_f32 v25, v25, v33
    v_sub_f32 v26, v26, v34
    v_sub_f32 v27, v27, v35
    v_sub_f32 v28, v28, v36
    v_sub_f32 v29, v29, v37
    v_sub_f32 v30, v30, v38
    v_sub_f32 v31, v31, v39
    v_cvt_pk_bf16_f32 v8, v24, v25
    v_cvt_pk_bf16_f32 v9, v26, v27
    v_cvt_pk_bf16_f32 v10, v28, v29
    v_cvt_pk_bf16_f32 v11, v30, v31
    v_lshlrev_b32 v24, 16, v8
    v_and_b32 v25, 0xffff0000, v8
    v_lshlrev_b32 v26, 16, v9
    v_and_b32 v27, 0xffff0000, v9
    v_lshlrev_b32 v28, 16, v10
    v_and_b32 v29, 0xffff0000, v10
    v_lshlrev_b32 v30, 16, v11
    v_and_b32 v31, 0xffff0000, v11
    s_waitcnt vmcnt(1)
    v_lshlrev_b32 v32, 16, v16
    v_and_b32 v33, 0xffff0000, v16
    v_lshlrev_b32 v34, 16, v17
    v_and_b32 v35, 0xffff0000, v17
    v_lshlrev_b32 v36, 16, v18
    v_and_b32 v37, 0xffff0000, v18
    v_lshlrev_b32 v38, 16, v19
    v_and_b32 v39, 0xffff0000, v19
    v_add_f32 v24, v24, v32
    v_add_f32 v25, v25, v33
    v_add_f32 v26, v26, v34
    v_add_f32 v27, v27, v35
    v_add_f32 v28, v28, v36
    v_add_f32 v29, v29, v37
    v_add_f32 v30, v30, v38
    v_add_f32 v31, v31, v39
    v_cvt_pk_bf16_f32 v8, v24, v25
    v_cvt_pk_bf16_f32 v9, v26, v27
    v_cvt_pk_bf16_f32 v10, v28, v29
    v_cvt_pk_bf16_f32 v11, v30, v31
    v_lshlrev_b32 v24, 16, v8
    v_and_b32 v25, 0xffff0000, v8
    v_lshlrev_b32 v26, 16, v9
    v_and_b32 v27, 0xffff0000, v9
    v_lshlrev_b32 v28, 16, v10
    v_and_b32 v29, 0xffff0000, v10
    v_lshlrev_b32 v30, 16, v11
    v_and_b32 v31, 0xffff0000, v11
    v_add_f32 v5, v24, v25
    v_add_f32 v6, v26, v27
    v_add_f32 v5, v5, v28
    v_add_f32 v6, v6, v29
    v_add_f32 v5, v5, v30
    v_add_f32 v6, v6, v31
    v_add_f32 v5, v5, v6
    s_nop 1
    v_add_f32_dpp v5, v5, v5 quad_perm:[1,0,3,2] row_mask:0xf bank_mask:0xf
    s_nop 1
    v_add_f32_dpp v5, v5, v5 quad_perm:[2,3,0,1] row_mask:0xf bank_mask:0xf
    s_nop 1
    v_add_f32_dpp v5, v5, v5 row_half_mirror row_mask:0xf bank_mask:0xf
    s_nop 1
    v_add_f32_dpp v5, v5, v5 row_mirror row_mask:0xf bank_mask:0xf
    v_mov_b32 v6, v5
    s_nop 1
    v_permlane16_swap_b32 v5, v6
    s_nop 1
    v_add_f32 v5, v5, v6
    v_mov_b32 v6, v5
    s_nop 1
    v_permlane32_swap_b32 v5, v6
    s_nop 1
    v_add_f32 v5, v5, v6
    v_mul_f32 v5, 0x3b000000, v5
    v_sub_f32 v32, v24, v5
    v_sub_f32 v33, v25, v5
    v_sub_f32 v34, v26, v5
    v_sub_f32 v35, v27, v5
    v_sub_f32 v36, v28, v5
    v_sub_f32 v37, v29, v5
    v_sub_f32 v38, v30, v5
    v_sub_f32 v39, v31, v5
    v_mul_f32 v6, v32, v32
    v_fmac_f32 v6, v33, v33
    v_fmac_f32 v6, v34, v34
    v_fmac_f32 v6, v35, v35
    v_fmac_f32 v6, v36, v36
    v_fmac_f32 v6, v37, v37
    v_fmac_f32 v6, v38, v38
    v_fmac_f32 v6, v39, v39
    s_nop 1
    v_add_f32_dpp v6, v6, v6 quad_perm:[1,0,3,2] row_mask:0xf bank_mask:0xf
    s_nop 1
    v_add_f32_dpp v6, v6, v6 quad_perm:[2,3,0,1] row_mask:0xf bank_mask:0xf
    s_nop 1
    v_add_f32_dpp v6, v6, v6 row_half_mirror row_mask:0xf bank_mask:0xf
    s_nop 1
    v_add_f32_dpp v6, v6, v6 row_mirror row_mask:0xf bank_mask:0xf
    v_mov_b32 v7, v6
    s_nop 1
    v_permlane16_swap_b32 v6, v7
    s_nop 1
    v_add_f32 v6, v6, v7
    v_mov_b32 v7, v6
    s_nop 1
    v_permlane32_swap_b32 v6, v7
    s_nop 1
    v_add_f32 v6, v6, v7
    v_mul_f32 v6, 0x3b000000, v6
    v_cvt_pk_bf16_f32 v6, v6, v6
    v_lshlrev_b32 v6, 16, v6
    v_add_f32 v6, 0x3727c5ac, v6
    v_cvt_pk_bf16_f32 v6, v6, v6
    v_lshlrev_b32 v6, 16, v6
    v_sqrt_f32 v6, v6
    s_nop 0
    v_cvt_pk_bf16_f32 v6, v6, v6
    v_lshlrev_b32 v6, 16, v6
    v_cvt_pk_bf16_f32 v5, v5, v5
    v_lshlrev_b32 v5, 16, v5
    v_lshrrev_b32 v49, 16, v5
    v_or_b32 v49, v49, v6
    v_rcp_f32 v6, v6
    v_sub_f32 v32, v24, v5
    v_sub_f32 v33, v25, v5
    v_sub_f32 v34, v26, v5
    v_sub_f32 v35, v27, v5
    v_sub_f32 v36, v28, v5
    v_sub_f32 v37, v29, v5
    v_sub_f32 v38, v30, v5
    v_sub_f32 v39, v31, v5
    v_cvt_pk_bf16_f32 v12, v32, v33
    v_cvt_pk_bf16_f32 v13, v34, v35
    v_cvt_pk_bf16_f32 v14, v36, v37
    v_cvt_pk_bf16_f32 v15, v38, v39
    v_lshlrev_b32 v32, 16, v12
    v_and_b32 v33, 0xffff0000, v12
    v_lshlrev_b32 v34, 16, v13
    v_and_b32 v35, 0xffff0000, v13
    v_lshlrev_b32 v36, 16, v14
    v_and_b32 v37, 0xffff0000, v14
    v_lshlrev_b32 v38, 16, v15
    v_and_b32 v39, 0xffff0000, v15
    v_mul_f32 v32, v32, v6
    v_mul_f32 v33, v33, v6
    v_mul_f32 v34, v34, v6
    v_mul_f32 v35, v35, v6
    v_mul_f32 v36, v36, v6
    v_mul_f32 v37, v37, v6
    v_mul_f32 v38, v38, v6
    v_mul_f32 v39, v39, v6
    v_cvt_pk_bf16_f32 v12, v32, v33
    v_cvt_pk_bf16_f32 v13, v34, v35
    v_cvt_pk_bf16_f32 v14, v36, v37
    v_cvt_pk_bf16_f32 v15, v38, v39
    v_lshlrev_b32 v32, 16, v12
    v_and_b32 v33, 0xffff0000, v12
    v_lshlrev_b32 v34, 16, v13
    v_and_b32 v35, 0xffff0000, v13
    v_lshlrev_b32 v36, 16, v14
    v_and_b32 v37, 0xffff0000, v14
    v_lshlrev_b32 v38, 16, v15
    v_and_b32 v39, 0xffff0000, v15
    s_waitcnt vmcnt(0)
    v_lshlrev_b32 v40, 16, v20
    v_and_b32 v41, 0xffff0000, v20
    v_lshlrev_b32 v42, 16, v21
    v_and_b32 v43, 0xffff0000, v21
    v_lshlrev_b32 v44, 16, v22
    v_and_b32 v45, 0xffff0000, v22
    v_lshlrev_b32 v46, 16, v23
    v_and_b32 v47, 0xffff0000, v23
    v_mul_f32 v7, v32, v40
    v_fmac_f32 v7, v33, v41
    v_fmac_f32 v7, v34, v42
    v_fmac_f32 v7, v35, v43
    v_fmac_f32 v7, v36, v44
    v_fmac_f32 v7, v37, v45
    v_fmac_f32 v7, v38, v46
    v_fmac_f32 v7, v39, v47
    s_nop 1
    v_add_f32_dpp v7, v7, v7 quad_perm:[1,0,3,2] row_mask:0xf bank_mask:0xf
    s_nop 1
    v_add_f32_dpp v7, v7, v7 quad_perm:[2,3,0,1] row_mask:0xf bank_mask:0xf
    s_nop 1
    v_add_f32_dpp v7, v7, v7 row_half_mirror row_mask:0xf bank_mask:0xf
    s_nop 1
    v_add_f32_dpp v7, v7, v7 row_mirror row_mask:0xf bank_mask:0xf
    v_mov_b32 v6, v7
    s_nop 1
    v_permlane16_swap_b32 v7, v6
    s_nop 1
    v_add_f32 v7, v7, v6
    v_mov_b32 v6, v7
    s_nop 1
    v_permlane32_swap_b32 v7, v6
    s_nop 1
    v_add_f32 v7, v7, v6
    v_cvt_pk_bf16_f32 v7, v7, v7
    v_and_b32 v7, 0xffff, v7
    v_xor_b32 v5, 0xffff, v7
    v_or_b32 v6, 0x8000, v7
    v_cmp_lt_u32 vcc, 0x7fff, v7
    s_nop 1
    v_cndmask_b32 v7, v6, v5, vcc
    v_lshlrev_b32 v7, 16, v7
    s_sub_u32 s34, 0xfff, s3
    v_or_b32 v48, s34, v7
    s_lshl_b32 s34, s3, 3
    s_add_u32 s34, s34, 6553600
    v_mov_b32 v5, s34
    s_mov_b64 exec, 1
    buffer_store_dwordx2 v[48:49], v5, s[28:31], 0 offen sc1
    s_mov_b64 exec, -1
    v_add_f32 v40, v24, v32
    v_add_f32 v41, v25, v33
    v_add_f32 v42, v26, v34
    v_add_f32 v43, v27, v35
    v_add_f32 v44, v28, v36
    v_add_f32 v45, v29, v37
    v_add_f32 v46, v30, v38
    v_add_f32 v47, v31, v39
    v_cvt_pk_bf16_f32 v16, v40, v41
    v_cvt_pk_bf16_f32 v17, v42, v43
    v_cvt_pk_bf16_f32 v18, v44, v45
    v_cvt_pk_bf16_f32 v19, v46, v47
    buffer_store_dwordx4 v[16:19], v4, s[24:27], 0 offen sc1
    s_lshl_b32 s34, s3, 2
    s_add_u32 s34, s34, 6571008
    v_mov_b32 v5, s34
    v_mov_b32 v6, 1
    s_waitcnt vmcnt(0)
    s_mov_b64 exec, 1
    buffer_store_dword v6, v5, s[28:31], 0 offen sc1
    s_mov_b64 exec, -1
    s_cmp_ge_u32 s2, 144
    s_cbranch_scc1 L_k3_fin
    s_cmp_ge_u32 s2, 112
    s_cbranch_scc1 L_k3_dn_dma
    s_mov_b32 s69, s2
    s_and_b32 s34, s69, 7
    s_mul_i32 s34, s34, 14
    s_lshr_b32 s35, s69, 3
    s_add_u32 s36, s34, s35
    s_lshl_b32 s36, s36, 5
    v_lshrrev_b32 v5, 1, v1
    s_lshl_b32 s34, s33, 6
    v_add_u32 v5, s34, v5
    s_movk_i32 s35, 3584
    v_mul_lo_u32 v5, v5, s35
    v_and_b32 v6, 1, v1
    v_lshl_add_u32 v5, v6, 4, v5
    v_add_u32 v5, s36, v5
    s_lshl_b32 s37, s33, 11
    s_mov_b32 s60, s42
    s_and_b32 s61, s43, 0xffff
    s_mov_b32 s62, 0x1c0000
    s_mov_b32 s63, 0x00020000
    s_mov_b32 s64, s44
    s_and_b32 s65, s45, 0xffff
    s_mov_b32 s66, 0x1c0000
    s_mov_b32 s67, 0x00020000
    s_add_u32 s38, s37, 0
    s_mov_b32 m0, s38
    s_mov_b32 s39, 0
    buffer_load_dwordx4 v5, s[60:63], s39 offen lds
    s_add_u32 s38, s37, 1024
    s_mov_b32 m0, s38
    s_mov_b32 s39, 114688
    buffer_load_dwordx4 v5, s[60:63], s39 offen lds
    s_add_u32 s38, s37, 16384
    s_mov_b32 m0, s38
    s_mov_b32 s39, 0
    buffer_load_dwordx4 v5, s[64:67], s39 offen lds
    s_add_u32 s38, s37, 17408
    s_mov_b32 m0, s38
    s_mov_b32 s39, 114688
    buffer_load_dwordx4 v5, s[64:67], s39 offen lds
    s_branch L_k3_poll
L_k3_dn_dma:
    s_sub_u32 s34, s2, 112
    s_and_b32 s35, s34, 7
    s_lshl_b32 s35, s35, 2
    s_lshr_b32 s34, s34, 3
    s_add_u32 s36, s35, s34
    s_lshl_b32 s36, s36, 5
    s_mul_i32 s34, s33, 224
    v_lshrrev_b32 v5, 1, v1
    v_add_u32 v5, s34, v5
    v_lshlrev_b32 v5, 10, v5
    v_and_b32 v6, 1, v1
    v_lshl_add_u32 v5, v6, 4, v5
    v_add_u32 v5, s36, v5
    s_mul_i32 s37, s33, 7*1024
    s_mov_b32 s60, s46
    s_and_b32 s61, s47, 0xffff
    s_mov_b32 s62, 0x1c0000
    s_mov_b32 s63, 0x00020000
    s_add_u32 s38, s37, 0
    s_mov_b32 m0, s38
    s_mov_b32 s39, 0
    buffer_load_dwordx4 v5, s[60:63], s39 offen lds
    s_add_u32 s38, s37, 1024
    s_mov_b32 m0, s38
    s_mov_b32 s39, 32768
    buffer_load_dwordx4 v5, s[60:63], s39 offen lds
    s_add_u32 s38, s37, 2048
    s_mov_b32 m0, s38
    s_mov_b32 s39, 65536
    buffer_load_dwordx4 v5, s[60:63], s39 offen lds
    s_add_u32 s38, s37, 3072
    s_mov_b32 m0, s38
    s_mov_b32 s39, 98304
    buffer_load_dwordx4 v5, s[60:63], s39 offen lds
    s_add_u32 s38, s37, 4096
    s_mov_b32 m0, s38
    s_mov_b32 s39, 131072
    buffer_load_dwordx4 v5, s[60:63], s39 offen lds
    s_add_u32 s38, s37, 5120
    s_mov_b32 m0, s38
    s_mov_b32 s39, 163840
    buffer_load_dwordx4 v5, s[60:63], s39 offen lds
    s_add_u32 s38, s37, 6144
    s_mov_b32 m0, s38
    s_mov_b32 s39, 196608
    buffer_load_dwordx4 v5, s[60:63], s39 offen lds
L_k3_poll:
    v_lshlrev_b32 v6, 5, v0
    v_add_u32 v6, 6553600, v6
    s_sleep 20
L_k3_poll_loop:
    buffer_load_dwordx4 v[8:11], v6, s[28:31], 0 offen sc1
    buffer_load_dwordx4 v[12:15], v6, s[28:31], 0 offen offset:16 sc1
    s_waitcnt vmcnt(0)
    v_min_u32 v7, v8, v10
    v_min3_u32 v7, v7, v12, v14
    v_cmp_eq_u32 vcc, 0, v7
    s_cbranch_vccz L_k3_poll_done
    s_sleep 8
    s_branch L_k3_poll_loop
L_k3_poll_done:
    s_mov_b32 s56, -1
    v_sub_u32 v16, s56, v8
    v_sub_u32 v17, s56, v10
    v_sub_u32 v18, s56, v12
    v_sub_u32 v19, s56, v14
    v_min3_u32 v16, v16, v17, v18
    v_min_u32 v16, v16, v19
    s_nop 1
    v_min_u32_dpp v16, v16, v16 quad_perm:[1,0,3,2] row_mask:0xf bank_mask:0xf
    s_nop 1
    v_min_u32_dpp v16, v16, v16 quad_perm:[2,3,0,1] row_mask:0xf bank_mask:0xf
    s_nop 1
    v_min_u32_dpp v16, v16, v16 row_half_mirror row_mask:0xf bank_mask:0xf
    s_nop 1
    v_min_u32_dpp v16, v16, v16 row_mirror row_mask:0xf bank_mask:0xf
    s_nop 0
    v_readlane_b32 s57, v16, 0
    v_readlane_b32 s58, v16, 16
    v_readlane_b32 s59, v16, 32
    v_readlane_b32 s68, v16, 48
    s_nop 0
    s_min_u32 s57, s57, s58
    s_min_u32 s57, s57, s59
    s_min_u32 s57, s57, s68
    s_sub_u32 s48, s56, s57
    s_sub_u32 s56, s48, 1
    s_nop 0
    v_sub_u32 v16, s56, v8
    v_sub_u32 v17, s56, v10
    v_sub_u32 v18, s56, v12
    v_sub_u32 v19, s56, v14
    v_min3_u32 v16, v16, v17, v18
    v_min_u32 v16, v16, v19
    s_nop 1
    v_min_u32_dpp v16, v16, v16 quad_perm:[1,0,3,2] row_mask:0xf bank_mask:0xf
    s_nop 1
    v_min_u32_dpp v16, v16, v16 quad_perm:[2,3,0,1] row_mask:0xf bank_mask:0xf
    s_nop 1
    v_min_u32_dpp v16, v16, v16 row_half_mirror row_mask:0xf bank_mask:0xf
    s_nop 1
    v_min_u32_dpp v16, v16, v16 row_mirror row_mask:0xf bank_mask:0xf
    s_nop 0
    v_readlane_b32 s57, v16, 0
    v_readlane_b32 s58, v16, 16
    v_readlane_b32 s59, v16, 32
    v_readlane_b32 s68, v16, 48
    s_nop 0
    s_min_u32 s57, s57, s58
    s_min_u32 s57, s57, s59
    s_min_u32 s57, s57, s68
    s_sub_u32 s49, s56, s57
    s_sub_u32 s56, s49, 1
    s_nop 0
    v_sub_u32 v16, s56, v8
    v_sub_u32 v17, s56, v10
    v_sub_u32 v18, s56, v12
    v_sub_u32 v19, s56, v14
    v_min3_u32 v16, v16, v17, v18
    v_min_u32 v16, v16, v19
    s_nop 1
    v_min_u32_dpp v16, v16, v16 quad_perm:[1,0,3,2] row_mask:0xf bank_mask:0xf
    s_nop 1
    v_min_u32_dpp v16, v16, v16 quad_perm:[2,3,0,1] row_mask:0xf bank_mask:0xf
    s_nop 1
    v_min_u32_dpp v16, v16, v16 row_half_mirror row_mask:0xf bank_mask:0xf
    s_nop 1
    v_min_u32_dpp v16, v16, v16 row_mirror row_mask:0xf bank_mask:0xf
    s_nop 0
    v_readlane_b32 s57, v16, 0
    v_readlane_b32 s58, v16, 16
    v_readlane_b32 s59, v16, 32
    v_readlane_b32 s68, v16, 48
    s_nop 0
    s_min_u32 s57, s57, s58
    s_min_u32 s57, s57, s59
    s_min_u32 s57, s57, s68
    s_sub_u32 s50, s56, s57
    s_sub_u32 s56, s50, 1
    s_nop 0
    v_sub_u32 v16, s56, v8
    v_sub_u32 v17, s56, v10
    v_sub_u32 v18, s56, v12
    v_sub_u32 v19, s56, v14
    v_min3_u32 v16, v16, v17, v18
    v_min_u32 v16, v16, v19
    s_nop 1
    v_min_u32_dpp v16, v16, v16 quad_perm:[1,0,3,2] row_mask:0xf bank_mask:0xf
    s_nop 1
    v_min_u32_dpp v16, v16, v16 quad_perm:[2,3,0,1] row_mask:0xf bank_mask:0xf
    s_nop 1
    v_min_u32_dpp v16, v16, v16 row_half_mirror row_mask:0xf bank_mask:0xf
    s_nop 1
    v_min_u32_dpp v16, v16, v16 row_mirror row_mask:0xf bank_mask:0xf
    s_nop 0
    v_readlane_b32 s57, v16, 0
    v_readlane_b32 s58, v16, 16
    v_readlane_b32 s59, v16, 32
    v_readlane_b32 s68, v16, 48
    s_nop 0
    s_min_u32 s57, s57, s58
    s_min_u32 s57, s57, s59
    s_min_u32 s57, s57, s68
    s_sub_u32 s51, s56, s57
    s_sub_u32 s56, s51, 1
    s_nop 0
    v_sub_u32 v16, s56, v8
    v_sub_u32 v17, s56, v10
    v_sub_u32 v18, s56, v12
    v_sub_u32 v19, s56, v14
    v_min3_u32 v16, v16, v17, v18
    v_min_u32 v16, v16, v19
    s_nop 1
    v_min_u32_dpp v16, v16, v16 quad_perm:[1,0,3,2] row_mask:0xf bank_mask:0xf
    s_nop 1
    v_min_u32_dpp v16, v16, v16 quad_perm:[2,3,0,1] row_mask:0xf bank_mask:0xf
    s_nop 1
    v_min_u32_dpp v16, v16, v16 row_half_mirror row_mask:0xf bank_mask:0xf
    s_nop 1
    v_min_u32_dpp v16, v16, v16 row_mirror row_mask:0xf bank_mask:0xf
    s_nop 0
    v_readlane_b32 s57, v16, 0
    v_readlane_b32 s58, v16, 16
    v_readlane_b32 s59, v16, 32
    v_readlane_b32 s68, v16, 48
    s_nop 0
    s_min_u32 s57, s57, s58
    s_min_u32 s57, s57, s59
    s_min_u32 s57, s57, s68
    s_sub_u32 s52, s56, s57
    s_sub_u32 s56, s52, 1
    s_nop 0
    v_sub_u32 v16, s56, v8
    v_sub_u32 v17, s56, v10
    v_sub_u32 v18, s56, v12
    v_sub_u32 v19, s56, v14
    v_min3_u32 v16, v16, v17, v18
    v_min_u32 v16, v16, v19
    s_nop 1
    v_min_u32_dpp v16, v16, v16 quad_perm:[1,0,3,2] row_mask:0xf bank_mask:0xf
    s_nop 1
    v_min_u32_dpp v16, v16, v16 quad_perm:[2,3,0,1] row_mask:0xf bank_mask:0xf
    s_nop 1
    v_min_u32_dpp v16, v16, v16 row_half_mirror row_mask:0xf bank_mask:0xf
    s_nop 1
    v_min_u32_dpp v16, v16, v16 row_mirror row_mask:0xf bank_mask:0xf
    s_nop 0
    v_readlane_b32 s57, v16, 0
    v_readlane_b32 s58, v16, 16
    v_readlane_b32 s59, v16, 32
    v_readlane_b32 s68, v16, 48
    s_nop 0
    s_min_u32 s57, s57, s58
    s_min_u32 s57, s57, s59
    s_min_u32 s57, s57, s68
    s_sub_u32 s53, s56, s57
    s_sub_u32 s56, s53, 1
    s_nop 0
    v_sub_u32 v16, s56, v8
    v_sub_u32 v17, s56, v10
    v_sub_u32 v18, s56, v12
    v_sub_u32 v19, s56, v14
    v_min3_u32 v16, v16, v17, v18
    v_min_u32 v16, v16, v19
    s_nop 1
    v_min_u32_dpp v16, v16, v16 quad_perm:[1,0,3,2] row_mask:0xf bank_mask:0xf
    s_nop 1
    v_min_u32_dpp v16, v16, v16 quad_perm:[2,3,0,1] row_mask:0xf bank_mask:0xf
    s_nop 1
    v_min_u32_dpp v16, v16, v16 row_half_mirror row_mask:0xf bank_mask:0xf
    s_nop 1
    v_min_u32_dpp v16, v16, v16 row_mirror row_mask:0xf bank_mask:0xf
    s_nop 0
    v_readlane_b32 s57, v16, 0
    v_readlane_b32 s58, v16, 16
    v_readlane_b32 s59, v16, 32
    v_readlane_b32 s68, v16, 48
    s_nop 0
    s_min_u32 s57, s57, s58
    s_min_u32 s57, s57, s59
    s_min_u32 s57, s57, s68
    s_sub_u32 s54, s56, s57
    s_sub_u32 s56, s54, 1
    s_nop 0
    v_sub_u32 v16, s56, v8
    v_sub_u32 v17, s56, v10
    v_sub_u32 v18, s56, v12
    v_sub_u32 v19, s56, v14
    v_min3_u32 v16, v16, v17, v18
    v_min_u32 v16, v16, v19
    s_nop 1
    v_min_u32_dpp v16, v16, v16 quad_perm:[1,0,3,2] row_mask:0xf bank_mask:0xf
    s_nop 1
    v_min_u32_dpp v16, v16, v16 quad_perm:[2,3,0,1] row_mask:0xf bank_mask:0xf
    s_nop 1
    v_min_u32_dpp v16, v16, v16 row_half_mirror row_mask:0xf bank_mask:0xf
    s_nop 1
    v_min_u32_dpp v16, v16, v16 row_mirror row_mask:0xf bank_mask:0xf
    s_nop 0
    v_readlane_b32 s57, v16, 0
    v_readlane_b32 s58, v16, 16
    v_readlane_b32 s59, v16, 32
    v_readlane_b32 s68, v16, 48
    s_nop 0
    s_min_u32 s57, s57, s58
    s_min_u32 s57, s57, s59
    s_min_u32 s57, s57, s68
    s_sub_u32 s55, s56, s57
    s_sub_u32 s56, s55, 1
    s_nop 0
    v_mov_b32 v7, 0
    v_writelane_b32 v7, s48, 0
    v_writelane_b32 v7, s49, 1
    v_writelane_b32 v7, s50, 2
    v_writelane_b32 v7, s51, 3
    v_writelane_b32 v7, s52, 4
    v_writelane_b32 v7, s53, 5
    v_writelane_b32 v7, s54, 6
    v_writelane_b32 v7, s55, 7
    s_lshl_b32 s38, s33, 5
    s_add_u32 s38, s38, 61440
    v_lshlrev_b32 v16, 2, v1
    v_add_u32 v17, s38, v16
    s_mov_b64 exec, 0xff
    ds_write_b32 v17, v7
    s_mov_b64 exec, -1
    s_waitcnt lgkmcnt(0)
    s_barrier
    v_add_u32 v16, 61440, v16
    ds_read_b32 v8, v16
    s_waitcnt lgkmcnt(0)
    s_mov_b32 s56, -1
    v_sub_u32 v16, s56, v8
    s_nop 1
    v_min_u32_dpp v16, v16, v16 quad_perm:[1,0,3,2] row_mask:0xf bank_mask:0xf
    s_nop 1
    v_min_u32_dpp v16, v16, v16 quad_perm:[2,3,0,1] row_mask:0xf bank_mask:0xf
    s_nop 1
    v_min_u32_dpp v16, v16, v16 row_half_mirror row_mask:0xf bank_mask:0xf
    s_nop 1
    v_min_u32_dpp v16, v16, v16 row_mirror row_mask:0xf bank_mask:0xf
    s_nop 0
    v_readlane_b32 s57, v16, 0
    v_readlane_b32 s58, v16, 16
    v_readlane_b32 s59, v16, 32
    v_readlane_b32 s68, v16, 48
    s_nop 0
    s_min_u32 s57, s57, s58
    s_min_u32 s57, s57, s59
    s_min_u32 s57, s57, s68
    s_sub_u32 s48, s56, s57
    s_sub_u32 s56, s48, 1
    s_nop 0
    v_sub_u32 v16, s56, v8
    s_nop 1
    v_min_u32_dpp v16, v16, v16 quad_perm:[1,0,3,2] row_mask:0xf bank_mask:0xf
    s_nop 1
    v_min_u32_dpp v16, v16, v16 quad_perm:[2,3,0,1] row_mask:0xf bank_mask:0xf
    s_nop 1
    v_min_u32_dpp v16, v16, v16 row_half_mirror row_mask:0xf bank_mask:0xf
    s_nop 1
    v_min_u32_dpp v16, v16, v16 row_mirror row_mask:0xf bank_mask:0xf
    s_nop 0
    v_readlane_b32 s57, v16, 0
    v_readlane_b32 s58, v16, 16
    v_readlane_b32 s59, v16, 32
    v_readlane_b32 s68, v16, 48
    s_nop 0
    s_min_u32 s57, s57, s58
    s_min_u32 s57, s57, s59
    s_min_u32 s57, s57, s68
    s_sub_u32 s49, s56, s57
    s_sub_u32 s56, s49, 1
    s_nop 0
    v_sub_u32 v16, s56, v8
    s_nop 1
    v_min_u32_dpp v16, v16, v16 quad_perm:[1,0,3,2] row_mask:0xf bank_mask:0xf
    s_nop 1
    v_min_u32_dpp v16, v16, v16 quad_perm:[2,3,0,1] row_mask:0xf bank_mask:0xf
    s_nop 1
    v_min_u32_dpp v16, v16, v16 row_half_mirror row_mask:0xf bank_mask:0xf
    s_nop 1
    v_min_u32_dpp v16, v16, v16 row_mirror row_mask:0xf bank_mask:0xf
    s_nop 0
    v_readlane_b32 s57, v16, 0
    v_readlane_b32 s58, v16, 16
    v_readlane_b32 s59, v16, 32
    v_readlane_b32 s68, v16, 48
    s_nop 0
    s_min_u32 s57, s57, s58
    s_min_u32 s57, s57, s59
    s_min_u32 s57, s57, s68
    s_sub_u32 s50, s56, s57
    s_sub_u32 s56, s50, 1
    s_nop 0
    v_sub_u32 v16, s56, v8
    s_nop 1
    v_min_u32_dpp v16, v16, v16 quad_perm:[1,0,3,2] row_mask:0xf bank_mask:0xf
    s_nop 1
    v_min_u32_dpp v16, v16, v16 quad_perm:[2,3,0,1] row_mask:0xf bank_mask:0xf
    s_nop 1
    v_min_u32_dpp v16, v16, v16 row_half_mirror row_mask:0xf bank_mask:0xf
    s_nop 1
    v_min_u32_dpp v16, v16, v16 row_mirror row_mask:0xf bank_mask:0xf
    s_nop 0
    v_readlane_b32 s57, v16, 0
    v_readlane_b32 s58, v16, 16
    v_readlane_b32 s59, v16, 32
    v_readlane_b32 s68, v16, 48
    s_nop 0
    s_min_u32 s57, s57, s58
    s_min_u32 s57, s57, s59
    s_min_u32 s57, s57, s68
    s_sub_u32 s51, s56, s57
    s_sub_u32 s56, s51, 1
    s_nop 0
    v_sub_u32 v16, s56, v8
    s_nop 1
    v_min_u32_dpp v16, v16, v16 quad_perm:[1,0,3,2] row_mask:0xf bank_mask:0xf
    s_nop 1
    v_min_u32_dpp v16, v16, v16 quad_perm:[2,3,0,1] row_mask:0xf bank_mask:0xf
    s_nop 1
    v_min_u32_dpp v16, v16, v16 row_half_mirror row_mask:0xf bank_mask:0xf
    s_nop 1
    v_min_u32_dpp v16, v16, v16 row_mirror row_mask:0xf bank_mask:0xf
    s_nop 0
    v_readlane_b32 s57, v16, 0
    v_readlane_b32 s58, v16, 16
    v_readlane_b32 s59, v16, 32
    v_readlane_b32 s68, v16, 48
    s_nop 0
    s_min_u32 s57, s57, s58
    s_min_u32 s57, s57, s59
    s_min_u32 s57, s57, s68
    s_sub_u32 s52, s56, s57
    s_sub_u32 s56, s52, 1
    s_nop 0
    v_sub_u32 v16, s56, v8
    s_nop 1
    v_min_u32_dpp v16, v16, v16 quad_perm:[1,0,3,2] row_mask:0xf bank_mask:0xf
    s_nop 1
    v_min_u32_dpp v16, v16, v16 quad_perm:[2,3,0,1] row_mask:0xf bank_mask:0xf
    s_nop 1
    v_min_u32_dpp v16, v16, v16 row_half_mirror row_mask:0xf bank_mask:0xf
    s_nop 1
    v_min_u32_dpp v16, v16, v16 row_mirror row_mask:0xf bank_mask:0xf
    s_nop 0
    v_readlane_b32 s57, v16, 0
    v_readlane_b32 s58, v16, 16
    v_readlane_b32 s59, v16, 32
    v_readlane_b32 s68, v16, 48
    s_nop 0
    s_min_u32 s57, s57, s58
    s_min_u32 s57, s57, s59
    s_min_u32 s57, s57, s68
    s_sub_u32 s53, s56, s57
    s_sub_u32 s56, s53, 1
    s_nop 0
    v_sub_u32 v16, s56, v8
    s_nop 1
    v_min_u32_dpp v16, v16, v16 quad_perm:[1,0,3,2] row_mask:0xf bank_mask:0xf
    s_nop 1
    v_min_u32_dpp v16, v16, v16 quad_perm:[2,3,0,1] row_mask:0xf bank_mask:0xf
    s_nop 1
    v_min_u32_dpp v16, v16, v16 row_half_mirror row_mask:0xf bank_mask:0xf
    s_nop 1
    v_min_u32_dpp v16, v16, v16 row_mirror row_mask:0xf bank_mask:0xf
    s_nop 0
    v_readlane_b32 s57, v16, 0
    v_readlane_b32 s58, v16, 16
    v_readlane_b32 s59, v16, 32
    v_readlane_b32 s68, v16, 48
    s_nop 0
    s_min_u32 s57, s57, s58
    s_min_u32 s57, s57, s59
    s_min_u32 s57, s57, s68
    s_sub_u32 s54, s56, s57
    s_sub_u32 s56, s54, 1
    s_nop 0
    v_sub_u32 v16, s56, v8
    s_nop 1
    v_min_u32_dpp v16, v16, v16 quad_perm:[1,0,3,2] row_mask:0xf bank_mask:0xf
    s_nop 1
    v_min_u32_dpp v16, v16, v16 quad_perm:[2,3,0,1] row_mask:0xf bank_mask:0xf
    s_nop 1
    v_min_u32_dpp v16, v16, v16 row_half_mirror row_mask:0xf bank_mask:0xf
    s_nop 1
    v_min_u32_dpp v16, v16, v16 row_mirror row_mask:0xf bank_mask:0xf
    s_nop 0
    v_readlane_b32 s57, v16, 0
    v_readlane_b32 s58, v16, 16
    v_readlane_b32 s59, v16, 32
    v_readlane_b32 s68, v16, 48
    s_nop 0
    s_min_u32 s57, s57, s58
    s_min_u32 s57, s57, s59
    s_min_u32 s57, s57, s68
    s_sub_u32 s55, s56, s57
    s_sub_u32 s56, s55, 1
    s_nop 0
    s_cmp_ge_u32 s2, 112
    s_cbranch_scc1 L_k3_dn
    v_mov_b32 v7, 0
    v_writelane_b32 v7, s48, 0
    v_writelane_b32 v7, s49, 1
    v_writelane_b32 v7, s50, 2
    v_writelane_b32 v7, s51, 3
    v_writelane_b32 v7, s52, 4
    v_writelane_b32 v7, s53, 5
    v_writelane_b32 v7, s54, 6
    v_writelane_b32 v7, s55, 7
    s_nop 0
    v_readlane_b32 s38, v7, s33
    s_and_b32 s38, s38, 0x7ff
    s_sub_u32 s38, 0x7ff, s38
    s_lshl_b32 s39, s38, 3
    s_add_u32 s39, s39, 6553600
    s_lshl_b32 s38, s38, 10
    v_add_u32 v4, s38, v3
    v_mov_b32 v5, s39
    buffer_load_dwordx4 v[8:11], v4, s[28:31], 0 offen
    buffer_load_dwordx4 v[12:15], v4, s[28:31], s32 offen
    buffer_load_dwordx4 v[16:19], v4, s[16:19], 0 offen
    buffer_load_dwordx2 v[20:21], v5, s[28:31], 0 offen sc1
    s_mul_i32 s38, s33, 1040
    s_add_u32 s38, s38, 32768
    v_add_u32 v22, s38, v3
    s_waitcnt vmcnt(2)
    v_lshlrev_b32 v24, 16, v8
    v_and_b32 v25, 0xffff0000, v8
    v_lshlrev_b32 v26, 16, v9
    v_and_b32 v27, 0xffff0000, v9
    v_lshlrev_b32 v28, 16, v10
    v_and_b32 v29, 0xffff0000, v10
    v_lshlrev_b32 v30, 16, v11
    v_and_b32 v31, 0xffff0000, v11
    v_lshlrev_b32 v32, 16, v12
    v_and_b32 v33, 0xffff0000, v12
    v_lshlrev_b32 v34, 16, v13
    v_and_b32 v35, 0xffff0000, v13
    v_lshlrev_b32 v36, 16, v14
    v_and_b32 v37, 0xffff0000, v14
    v_lshlrev_b32 v38, 16, v15
    v_and_b32 v39, 0xffff0000, v15
    v_sub_f32 v24, v24, v32
    v_sub_f32 v25, v25, v33
    v_sub_f32 v26, v26, v34
    v_sub_f32 v27, v27, v35
    v_sub_f32 v28, v28, v36
    v_sub_f32 v29, v29, v37
    v_sub_f32 v30, v30, v38
    v_sub_f32 v31, v31, v39
    v_cvt_pk_bf16_f32 v8, v24, v25
    v_cvt_pk_bf16_f32 v9, v26, v27
    v_cvt_pk_bf16_f32 v10, v28, v29
    v_cvt_pk_bf16_f32 v11, v30, v31
    v_lshlrev_b32 v24, 16, v8
    v_and_b32 v25, 0xffff0000, v8
    v_lshlrev_b32 v26, 16, v9
    v_and_b32 v27, 0xffff0000, v9
    v_lshlrev_b32 v28, 16, v10
    v_and_b32 v29, 0xffff0000, v10
    v_lshlrev_b32 v30, 16, v11
    v_and_b32 v31, 0xffff0000, v11
    s_waitcnt vmcnt(1)
    v_lshlrev_b32 v32, 16, v16
    v_and_b32 v33, 0xffff0000, v16
    v_lshlrev_b32 v34, 16, v17
    v_and_b32 v35, 0xffff0000, v17
    v_lshlrev_b32 v36, 16, v18
    v_and_b32 v37, 0xffff0000, v18
    v_lshlrev_b32 v38, 16, v19
    v_and_b32 v39, 0xffff0000, v19
    v_add_f32 v24, v24, v32
    v_add_f32 v25, v25, v33
    v_add_f32 v26, v26, v34
    v_add_f32 v27, v27, v35
    v_add_f32 v28, v28, v36
    v_add_f32 v29, v29, v37
    v_add_f32 v30, v30, v38
    v_add_f32 v31, v31, v39
    v_cvt_pk_bf16_f32 v8, v24, v25
    v_cvt_pk_bf16_f32 v9, v26, v27
    v_cvt_pk_bf16_f32 v10, v28, v29
    v_cvt_pk_bf16_f32 v11, v30, v31
    v_lshlrev_b32 v24, 16, v8
    v_and_b32 v25, 0xffff0000, v8
    v_lshlrev_b32 v26, 16, v9
    v_and_b32 v27, 0xffff0000, v9
    v_lshlrev_b32 v28, 16, v10
    v_and_b32 v29, 0xffff0000, v10
    v_lshlrev_b32 v30, 16, v11
    v_and_b32 v31, 0xffff0000, v11
    s_waitcnt vmcnt(0)
    v_lshlrev_b32 v5, 16, v21
    v_and_b32 v6, 0xffff0000, v21
    v_rcp_f32 v6, v6
    v_sub_f32 v32, v24, v5
    v_sub_f32 v33, v25, v5
    v_sub_f32 v34, v26, v5
    v_sub_f32 v35, v27, v5
    v_sub_f32 v36, v28, v5
    v_sub_f32 v37, v29, v5
    v_sub_f32 v38, v30, v5
    v_sub_f32 v39, v31, v5
    v_cvt_pk_bf16_f32 v12, v32, v33
    v_cvt_pk_bf16_f32 v13, v34, v35
    v_cvt_pk_bf16_f32 v14, v36, v37
    v_cvt_pk_bf16_f32 v15, v38, v39
    v_lshlrev_b32 v32, 16, v12
    v_and_b32 v33, 0xffff0000, v12
    v_lshlrev_b32 v34, 16, v13
    v_and_b32 v35, 0xffff0000, v13
    v_lshlrev_b32 v36, 16, v14
    v_and_b32 v37, 0xffff0000, v14
    v_lshlrev_b32 v38, 16, v15
    v_and_b32 v39, 0xffff0000, v15
    v_mul_f32 v32, v32, v6
    v_mul_f32 v33, v33, v6
    v_mul_f32 v34, v34, v6
    v_mul_f32 v35, v35, v6
    v_mul_f32 v36, v36, v6
    v_mul_f32 v37, v37, v6
    v_mul_f32 v38, v38, v6
    v_mul_f32 v39, v39, v6
    v_cvt_pk_bf16_f32 v12, v32, v33
    v_cvt_pk_bf16_f32 v13, v34, v35
    v_cvt_pk_bf16_f32 v14, v36, v37
    v_cvt_pk_bf16_f32 v15, v38, v39
    ds_write_b128 v22, v[12:15]
    v_and_b32 v8, 7, v1
    s_movk_i32 s38, 1040
    v_mul_lo_u32 v8, v8, s38
    v_lshrrev_b32 v9, 4, v1
    v_lshl_add_u32 v8, v9, 3, v8
    s_lshl_b32 s38, s33, 7
    s_add_u32 s38, s38, 32768
    v_add_u32 v8, s38, v8
    v_lshlrev_b32 v10, 3, v1
    v_add_u32 v10, s37, v10
    s_waitcnt lgkmcnt(0)
    s_barrier
    ds_read_b64 v[32:33], v8 offset:0
    ds_read_b64 v[34:35], v8 offset:32
    ds_read_b64 v[36:37], v8 offset:64
    ds_read_b64 v[38:39], v8 offset:96
    ds_read_b64_tr_b16 v[48:49], v10 offset:0
    ds_read_b64_tr_b16 v[50:51], v10 offset:512
    ds_read_b64_tr_b16 v[52:53], v10 offset:1024
    ds_read_b64_tr_b16 v[54:55], v10 offset:1536
    ds_read_b64_tr_b16 v[56:57], v10 offset:16384
    ds_read_b64_tr_b16 v[58:59], v10 offset:16896
    ds_read_b64_tr_b16 v[60:61], v10 offset:17408
    ds_read_b64_tr_b16 v[62:63], v10 offset:17920
    s_waitcnt lgkmcnt(0)
    v_mfma_f32_16x16x32_bf16 v[80:83], v[32:35], v[48:51], 0
    v_mfma_f32_16x16x32_bf16 v[84:87], v[32:35], v[56:59], 0
    v_mfma_f32_16x16x32_bf16 v[80:83], v[36:39], v[52:55], v[80:83]
    v_mfma_f32_16x16x32_bf16 v[84:87], v[36:39], v[60:63], v[84:87]
    s_lshl_b32 s38, s33, 10
    s_add_u32 s38, s38, 41472
    v_add_u32 v12, s38, v3
    s_nop 7
    s_mov_b64 exec, 0xffffffff
    ds_write_b128 v12, v[80:83]
    ds_write_b128 v12, v[84:87] offset:512
    s_mov_b64 exec, -1
    s_waitcnt lgkmcnt(0)
    s_barrier
    s_cmp_lg_u32 s33, 0
    s_cbranch_scc1 L_k3_fin
    s_mov_b64 exec, 0xffffffff
    ds_read_b128 v[32:35], v3 offset:41472
    ds_read_b128 v[36:39], v3 offset:41984
    ds_read_b128 v[40:43], v3 offset:42496
    ds_read_b128 v[44:47], v3 offset:43008
    ds_read_b128 v[48:51], v3 offset:43520
    ds_read_b128 v[52:55], v3 offset:44032
    ds_read_b128 v[56:59], v3 offset:44544
    ds_read_b128 v[60:63], v3 offset:45056
    ds_read_b128 v[64:67], v3 offset:45568
    ds_read_b128 v[68:71], v3 offset:46080
    ds_read_b128 v[72:75], v3 offset:46592
    ds_read_b128 v[76:79], v3 offset:47104
    ds_read_b128 v[80:83], v3 offset:47616
    ds_read_b128 v[84:87], v3 offset:48128
    ds_read_b128 v[88:91], v3 offset:48640
    ds_read_b128 v[92:95], v3 offset:49152
    s_waitcnt lgkmcnt(0)
    v_add_f32 v32, v32, v40
    v_add_f32 v48, v48, v56
    v_add_f32 v64, v64, v72
    v_add_f32 v80, v80, v88
    v_add_f32 v32, v32, v48
    v_add_f32 v64, v64, v80
    v_add_f32 v32, v32, v64
    v_cvt_pk_bf16_f32 v32, v32, v32
    v_lshlrev_b32 v32, 16, v32
    v_add_f32 v33, v33, v41
    v_add_f32 v49, v49, v57
    v_add_f32 v65, v65, v73
    v_add_f32 v81, v81, v89
    v_add_f32 v33, v33, v49
    v_add_f32 v65, v65, v81
    v_add_f32 v33, v33, v65
    v_cvt_pk_bf16_f32 v33, v33, v33
    v_lshlrev_b32 v33, 16, v33
    v_add_f32 v34, v34, v42
    v_add_f32 v50, v50, v58
    v_add_f32 v66, v66, v74
    v_add_f32 v82, v82, v90
    v_add_f32 v34, v34, v50
    v_add_f32 v66, v66, v82
    v_add_f32 v34, v34, v66
    v_cvt_pk_bf16_f32 v34, v34, v34
    v_lshlrev_b32 v34, 16, v34
    v_add_f32 v35, v35, v43
    v_add_f32 v51, v51, v59
    v_add_f32 v67, v67, v75
    v_add_f32 v83, v83, v91
    v_add_f32 v35, v35, v51
    v_add_f32 v67, v67, v83
    v_add_f32 v35, v35, v67
    v_cvt_pk_bf16_f32 v35, v35, v35
    v_lshlrev_b32 v35, 16, v35
    v_add_f32 v36, v36, v44
    v_add_f32 v52, v52, v60
    v_add_f32 v68, v68, v76
    v_add_f32 v84, v84, v92
    v_add_f32 v36, v36, v52
    v_add_f32 v68, v68, v84
    v_add_f32 v36, v36, v68
    v_cvt_pk_bf16_f32 v36, v36, v36
    v_lshlrev_b32 v36, 16, v36
    v_add_f32 v37, v37, v45
    v_add_f32 v53, v53, v61
    v_add_f32 v69, v69, v77
    v_add_f32 v85, v85, v93
    v_add_f32 v37, v37, v53
    v_add_f32 v69, v69, v85
    v_add_f32 v37, v37, v69
    v_cvt_pk_bf16_f32 v37, v37, v37
    v_lshlrev_b32 v37, 16, v37
    v_add_f32 v38, v38, v46
    v_add_f32 v54, v54, v62
    v_add_f32 v70, v70, v78
    v_add_f32 v86, v86, v94
    v_add_f32 v38, v38, v54
    v_add_f32 v70, v70, v86
    v_add_f32 v38, v38, v70
    v_cvt_pk_bf16_f32 v38, v38, v38
    v_lshlrev_b32 v38, 16, v38
    v_add_f32 v39, v39, v47
    v_add_f32 v55, v55, v63
    v_add_f32 v71, v71, v79
    v_add_f32 v87, v87, v95
    v_add_f32 v39, v39, v55
    v_add_f32 v71, v71, v87
    v_add_f32 v39, v39, v71
    v_cvt_pk_bf16_f32 v39, v39, v39
    v_lshlrev_b32 v39, 16, v39
    v_mul_f32 v40, 0xbfb8aa3b, v32
    v_exp_f32 v40, v40
    s_nop 0
    v_add_f32 v40, 1.0, v40
    v_rcp_f32 v40, v40
    s_nop 0
    v_mul_f32 v32, v32, v40
    v_cvt_pk_bf16_f32 v32, v32, v32
    v_lshlrev_b32 v32, 16, v32
    v_mul_f32 v32, v32, v36
    v_cvt_pk_bf16_f32 v32, v32, v32
    v_and_b32 v32, 0xffff, v32
    v_min_u32 v32, 0xfffe, v32
    v_mul_f32 v41, 0xbfb8aa3b, v33
    v_exp_f32 v41, v41
    s_nop 0
    v_add_f32 v41, 1.0, v41
    v_rcp_f32 v41, v41
    s_nop 0
    v_mul_f32 v33, v33, v41
    v_cvt_pk_bf16_f32 v33, v33, v33
    v_lshlrev_b32 v33, 16, v33
    v_mul_f32 v33, v33, v37
    v_cvt_pk_bf16_f32 v33, v33, v33
    v_and_b32 v33, 0xffff, v33
    v_min_u32 v33, 0xfffe, v33
    v_mul_f32 v42, 0xbfb8aa3b, v34
    v_exp_f32 v42, v42
    s_nop 0
    v_add_f32 v42, 1.0, v42
    v_rcp_f32 v42, v42
    s_nop 0
    v_mul_f32 v34, v34, v42
    v_cvt_pk_bf16_f32 v34, v34, v34
    v_lshlrev_b32 v34, 16, v34
    v_mul_f32 v34, v34, v38
    v_cvt_pk_bf16_f32 v34, v34, v34
    v_and_b32 v34, 0xffff, v34
    v_min_u32 v34, 0xfffe, v34
    v_mul_f32 v43, 0xbfb8aa3b, v35
    v_exp_f32 v43, v43
    s_nop 0
    v_add_f32 v43, 1.0, v43
    v_rcp_f32 v43, v43
    s_nop 0
    v_mul_f32 v35, v35, v43
    v_cvt_pk_bf16_f32 v35, v35, v35
    v_lshlrev_b32 v35, 16, v35
    v_mul_f32 v35, v35, v39
    v_cvt_pk_bf16_f32 v35, v35, v35
    v_and_b32 v35, 0xffff, v35
    v_min_u32 v35, 0xfffe, v35
    v_lshrrev_b32 v9, 4, v1
    s_movk_i32 s38, 3584*4
    v_mul_lo_u32 v9, v9, s38
    v_and_b32 v10, 15, v1
    v_lshl_add_u32 v9, v10, 1, v9
    s_add_u32 s38, s36, 6356992
    v_add_u32 v9, s38, v9
    s_mov_b32 s39, 0
    buffer_store_short v32, v9, s[28:31], s39 offen sc1
    s_mov_b32 s39, 3584
    buffer_store_short v33, v9, s[28:31], s39 offen sc1
    s_mov_b32 s39, 7168
    buffer_store_short v34, v9, s[28:31], s39 offen sc1
    s_mov_b32 s39, 10752
    buffer_store_short v35, v9, s[28:31], s39 offen sc1
    s_branch L_k3_fin
L_k3_dn:
    v_mov_b32 v16, 0
    v_mov_b32 v17, 0
    v_mov_b32 v18, 0
    v_mov_b32 v19, 0
    s_cmp_lg_u32 s33, 0
    s_cbranch_scc1 L_k3_dn_nog
    v_cmp_lt_u32 vcc, 15, v1
    v_and_b32 v10, 15, v1
    v_lshlrev_b32 v10, 1, v10
    v_add_u32 v10, s36, v10
    v_mov_b32 v12, s48
    v_mov_b32 v24, s52
    v_cndmask_b32 v12, v12, v24, vcc
    v_and_b32 v16, 0x7ff, v12
    v_sub_u32 v16, 0x7ff, v16
    v_lshlrev_b32 v20, 3, v16
    v_add_u32 v20, 6553604, v20
    v_lshl_add_u32 v16, v16, 10, v10
    v_mov_b32 v13, s49
    v_mov_b32 v24, s53
    v_cndmask_b32 v13, v13, v24, vcc
    v_and_b32 v17, 0x7ff, v13
    v_sub_u32 v17, 0x7ff, v17
    v_lshlrev_b32 v21, 3, v17
    v_add_u32 v21, 6553604, v21
    v_lshl_add_u32 v17, v17, 10, v10
    v_mov_b32 v14, s50
    v_mov_b32 v24, s54
    v_cndmask_b32 v14, v14, v24, vcc
    v_and_b32 v18, 0x7ff, v14
    v_sub_u32 v18, 0x7ff, v18
    v_lshlrev_b32 v22, 3, v18
    v_add_u32 v22, 6553604, v22
    v_lshl_add_u32 v18, v18, 10, v10
    v_mov_b32 v15, s51
    v_mov_b32 v24, s55
    v_cndmask_b32 v15, v15, v24, vcc
    v_and_b32 v19, 0x7ff, v15
    v_sub_u32 v19, 0x7ff, v19
    v_lshlrev_b32 v23, 3, v19
    v_add_u32 v23, 6553604, v23
    v_lshl_add_u32 v19, v19, 10, v10
    s_mov_b64 exec, 0xffffffff
    buffer_load_ushort v96, v16, s[28:31], 0 offen
    buffer_load_ushort v100, v16, s[28:31], s32 offen
    buffer_load_dword v104, v20, s[28:31], 0 offen sc1
    buffer_load_ushort v108, v16, s[16:19], 0 offen
    buffer_load_ushort v97, v17, s[28:31], 0 offen
    buffer_load_ushort v101, v17, s[28:31], s32 offen
    buffer_load_dword v105, v21, s[28:31], 0 offen sc1
    buffer_load_ushort v109, v17, s[16:19], 0 offen
    buffer_load_ushort v98, v18, s[28:31], 0 offen
    buffer_load_ushort v102, v18, s[28:31], s32 offen
    buffer_load_dword v106, v22, s[28:31], 0 offen sc1
    buffer_load_ushort v110, v18, s[16:19], 0 offen
    buffer_load_ushort v99, v19, s[28:31], 0 offen
    buffer_load_ushort v103, v19, s[28:31], s32 offen
    buffer_load_dword v107, v23, s[28:31], 0 offen sc1
    buffer_load_ushort v111, v19, s[16:19], 0 offen
    s_mov_b64 exec, -1
L_k3_dn_nog:
    s_cmp_lg_u32 s33, 0
    s_cbranch_scc1 L_k3_fl_wait
    v_mov_b32 v6, 0
    v_writelane_b32 v6, s48, 0
    v_writelane_b32 v6, s49, 1
    v_writelane_b32 v6, s50, 2
    v_writelane_b32 v6, s51, 3
    v_writelane_b32 v6, s52, 4
    v_writelane_b32 v6, s53, 5
    v_writelane_b32 v6, s54, 6
    v_writelane_b32 v6, s55, 7
    v_mov_b32 v7, s48
    v_cmp_gt_u32 vcc, 8, v1
    s_nop 1
    v_cndmask_b32 v6, v7, v6, vcc
    v_and_b32 v6, 0x7ff, v6
    v_sub_u32 v6, 0x7ff, v6
    v_lshlrev_b32 v6, 2, v6
    v_add_u32 v6, 6571008, v6
L_k3_fl_loop:
    buffer_load_dword v8, v6, s[28:31], 0 offen sc1
    s_waitcnt vmcnt(0)
    v_cmp_eq_u32 vcc, 0, v8
    s_cbranch_vccz L_k3_fl_ok
    s_sleep 8
    s_branch L_k3_fl_loop
L_k3_fl_ok:
    v_lshlrev_b32 v96, 16, v96
    v_lshlrev_b32 v100, 16, v100
    v_lshlrev_b32 v108, 16, v108
    v_sub_f32 v96, v96, v100
    v_cvt_pk_bf16_f32 v96, v96, v96
    v_lshlrev_b32 v96, 16, v96
    v_add_f32 v96, v96, v108
    v_cvt_pk_bf16_f32 v96, v96, v96
    v_lshlrev_b32 v96, 16, v96
    v_lshlrev_b32 v100, 16, v104
    v_and_b32 v104, 0xffff0000, v104
    v_rcp_f32 v104, v104
    v_sub_f32 v100, v96, v100
    v_cvt_pk_bf16_f32 v100, v100, v100
    v_lshlrev_b32 v100, 16, v100
    v_mul_f32 v100, v100, v104
    v_cvt_pk_bf16_f32 v100, v100, v100
    v_lshlrev_b32 v100, 16, v100
    v_lshrrev_b32 v24, 16, v12
    v_and_b32 v25, 0x7fff, v24
    v_xor_b32 v26, 0xffff, v24
    v_cmp_lt_u32 vcc, 0x7fff, v24
    s_nop 1
    v_cndmask_b32 v24, v26, v25, vcc
    v_lshlrev_b32 v24, 16, v24
    v_mul_f32 v24, 0xbfb8aa3b, v24
    v_exp_f32 v24, v24
    s_nop 0
    v_add_f32 v24, 1.0, v24
    v_rcp_f32 v104, v24
    s_nop 0
    v_cvt_pk_bf16_f32 v104, v104, v104
    v_lshlrev_b32 v104, 16, v104
    v_lshlrev_b32 v97, 16, v97
    v_lshlrev_b32 v101, 16, v101
    v_lshlrev_b32 v109, 16, v109
    v_sub_f32 v97, v97, v101
    v_cvt_pk_bf16_f32 v97, v97, v97
    v_lshlrev_b32 v97, 16, v97
    v_add_f32 v97, v97, v109
    v_cvt_pk_bf16_f32 v97, v97, v97
    v_lshlrev_b32 v97, 16, v97
    v_lshlrev_b32 v101, 16, v105
    v_and_b32 v105, 0xffff0000, v105
    v_rcp_f32 v105, v105
    v_sub_f32 v101, v97, v101
    v_cvt_pk_bf16_f32 v101, v101, v101
    v_lshlrev_b32 v101, 16, v101
    v_mul_f32 v101, v101, v105
    v_cvt_pk_bf16_f32 v101, v101, v101
    v_lshlrev_b32 v101, 16, v101
    v_lshrrev_b32 v24, 16, v13
    v_and_b32 v25, 0x7fff, v24
    v_xor_b32 v26, 0xffff, v24
    v_cmp_lt_u32 vcc, 0x7fff, v24
    s_nop 1
    v_cndmask_b32 v24, v26, v25, vcc
    v_lshlrev_b32 v24, 16, v24
    v_mul_f32 v24, 0xbfb8aa3b, v24
    v_exp_f32 v24, v24
    s_nop 0
    v_add_f32 v24, 1.0, v24
    v_rcp_f32 v105, v24
    s_nop 0
    v_cvt_pk_bf16_f32 v105, v105, v105
    v_lshlrev_b32 v105, 16, v105
    v_lshlrev_b32 v98, 16, v98
    v_lshlrev_b32 v102, 16, v102
    v_lshlrev_b32 v110, 16, v110
    v_sub_f32 v98, v98, v102
    v_cvt_pk_bf16_f32 v98, v98, v98
    v_lshlrev_b32 v98, 16, v98
    v_add_f32 v98, v98, v110
    v_cvt_pk_bf16_f32 v98, v98, v98
    v_lshlrev_b32 v98, 16, v98
    v_lshlrev_b32 v102, 16, v106
    v_and_b32 v106, 0xffff0000, v106
    v_rcp_f32 v106, v106
    v_sub_f32 v102, v98, v102
    v_cvt_pk_bf16_f32 v102, v102, v102
    v_lshlrev_b32 v102, 16, v102
    v_mul_f32 v102, v102, v106
    v_cvt_pk_bf16_f32 v102, v102, v102
    v_lshlrev_b32 v102, 16, v102
    v_lshrrev_b32 v24, 16, v14
    v_and_b32 v25, 0x7fff, v24
    v_xor_b32 v26, 0xffff, v24
    v_cmp_lt_u32 vcc, 0x7fff, v24
    s_nop 1
    v_cndmask_b32 v24, v26, v25, vcc
    v_lshlrev_b32 v24, 16, v24
    v_mul_f32 v24, 0xbfb8aa3b, v24
    v_exp_f32 v24, v24
    s_nop 0
    v_add_f32 v24, 1.0, v24
    v_rcp_f32 v106, v24
    s_nop 0
    v_cvt_pk_bf16_f32 v106, v106, v106
    v_lshlrev_b32 v106, 16, v106
    v_lshlrev_b32 v99, 16, v99
    v_lshlrev_b32 v103, 16, v103
    v_lshlrev_b32 v111, 16, v111
    v_sub_f32 v99, v99, v103
    v_cvt_pk_bf16_f32 v99, v99, v99
    v_lshlrev_b32 v99, 16, v99
    v_add_f32 v99, v99, v111
    v_cvt_pk_bf16_f32 v99, v99, v99
    v_lshlrev_b32 v99, 16, v99
    v_lshlrev_b32 v103, 16, v107
    v_and_b32 v107, 0xffff0000, v107
    v_rcp_f32 v107, v107
    v_sub_f32 v103, v99, v103
    v_cvt_pk_bf16_f32 v103, v103, v103
    v_lshlrev_b32 v103, 16, v103
    v_mul_f32 v103, v103, v107
    v_cvt_pk_bf16_f32 v103, v103, v103
    v_lshlrev_b32 v103, 16, v103
    v_lshrrev_b32 v24, 16, v15
    v_and_b32 v25, 0x7fff, v24
    v_xor_b32 v26, 0xffff, v24
    v_cmp_lt_u32 vcc, 0x7fff, v24
    s_nop 1
    v_cndmask_b32 v24, v26, v25, vcc
    v_lshlrev_b32 v24, 16, v24
    v_mul_f32 v24, 0xbfb8aa3b, v24
    v_exp_f32 v24, v24
    s_nop 0
    v_add_f32 v24, 1.0, v24
    v_rcp_f32 v107, v24
    s_nop 0
    v_cvt_pk_bf16_f32 v107, v107, v107
    v_lshlrev_b32 v107, 16, v107
L_k3_fl_wait:
    v_lshlrev_b32 v7, 3, v1
    v_add_u32 v7, s37, v7
    s_waitcnt vmcnt(0)
    ds_read_b64_tr_b16 v[64:65], v7 offset:0
    ds_read_b64_tr_b16 v[66:67], v7 offset:512
    ds_read_b64_tr_b16 v[68:69], v7 offset:1024
    ds_read_b64_tr_b16 v[70:71], v7 offset:1536
    ds_read_b64_tr_b16 v[72:73], v7 offset:2048
    ds_read_b64_tr_b16 v[74:75], v7 offset:2560
    ds_read_b64_tr_b16 v[76:77], v7 offset:3072
    ds_read_b64_tr_b16 v[78:79], v7 offset:3584
    ds_read_b64_tr_b16 v[80:81], v7 offset:4096
    ds_read_b64_tr_b16 v[82:83], v7 offset:4608
    ds_read_b64_tr_b16 v[84:85], v7 offset:5120
    ds_read_b64_tr_b16 v[86:87], v7 offset:5632
    ds_read_b64_tr_b16 v[88:89], v7 offset:6144
    ds_read_b64_tr_b16 v[90:91], v7 offset:6656
    s_waitcnt lgkmcnt(0)
    s_barrier
    s_mul_i32 s38, s33, 3584
    s_add_u32 s38, s38, 6356992
    v_add_u32 v5, s38, v3
    s_mul_i32 s38, s33, 3600
    s_add_u32 s38, s38, 0
    v_add_u32 v6, s38, v3
    v_mov_b32 v44, 0
    v_mov_b32 v45, 0
    v_mov_b32 v46, 0
    v_mov_b32 v47, 0
    s_sleep 36
L_k3_act_loop:
    buffer_load_dwordx4 v[32:35], v5, s[28:31], 0 offen offset:0 sc1
    buffer_load_dwordx4 v[36:39], v5, s[28:31], 0 offen offset:1024 sc1
    buffer_load_dwordx4 v[40:43], v5, s[28:31], 0 offen offset:2048 sc1
    s_mov_b64 exec, 0xffffffff
    buffer_load_dwordx4 v[44:47], v5, s[28:31], 0 offen offset:3072 sc1
    s_mov_b64 exec, -1
    s_waitcnt vmcnt(0)
    v_pk_max_u16 v8, v32, v33
    v_pk_max_u16 v8, v8, v34
    v_pk_max_u16 v8, v8, v35
    v_pk_max_u16 v8, v8, v36
    v_pk_max_u16 v8, v8, v37
    v_pk_max_u16 v8, v8, v38
    v_pk_max_u16 v8, v8, v39
    v_pk_max_u16 v8, v8, v40
    v_pk_max_u16 v8, v8, v41
    v_pk_max_u16 v8, v8, v42
    v_pk_max_u16 v8, v8, v43
    v_pk_max_u16 v8, v8, v44
    v_pk_max_u16 v8, v8, v45
    v_pk_max_u16 v8, v8, v46
    v_pk_max_u16 v8, v8, v47
    v_lshrrev_b32 v9, 16, v8
    v_and_b32 v8, 0xffff, v8
    v_max_u32 v8, v8, v9
    v_cmp_eq_u32 vcc, 0xffff, v8
    s_cbranch_vccz L_k3_act_done
    s_sleep 4
    s_branch L_k3_act_loop
L_k3_act_done:
    ds_write_b128 v6, v[32:35] offset:0
    ds_write_b128 v6, v[36:39] offset:1024
    ds_write_b128 v6, v[40:43] offset:2048
    s_mov_b64 exec, 0xffffffff
    ds_write_b128 v6, v[44:47] offset:3072
    s_mov_b64 exec, -1
    v_lshlrev_b32 v7, 3, v1
    v_add_u32 v7, s37, v7
    v_and_b32 v5, 7, v1
    s_movk_i32 s38, 3600
    v_mul_lo_u32 v5, v5, s38
    v_lshrrev_b32 v6, 4, v1
    v_lshl_add_u32 v5, v6, 3, v5
    s_mul_i32 s38, s33, 448
    s_add_u32 s38, s38, 0
    v_add_u32 v5, s38, v5
    s_waitcnt lgkmcnt(0)
    s_barrier
    ds_read_b64 v[32:33], v5 offset:0
    ds_read_b64 v[34:35], v5 offset:32
    ds_read_b64 v[36:37], v5 offset:64
    ds_read_b64 v[38:39], v5 offset:96
    ds_read_b64 v[40:41], v5 offset:128
    ds_read_b64 v[42:43], v5 offset:160
    ds_read_b64 v[44:45], v5 offset:192
    ds_read_b64 v[46:47], v5 offset:224
    ds_read_b64 v[48:49], v5 offset:256
    ds_read_b64 v[50:51], v5 offset:288
    ds_read_b64 v[52:53], v5 offset:320
    ds_read_b64 v[54:55], v5 offset:352
    ds_read_b64 v[56:57], v5 offset:384
    ds_read_b64 v[58:59], v5 offset:416
    s_waitcnt lgkmcnt(0)
    v_mfma_f32_16x16x32_bf16 v[24:27], v[32:35], v[64:67], 0
    v_mfma_f32_16x16x32_bf16 v[24:27], v[36:39], v[68:71], v[24:27]
    v_mfma_f32_16x16x32_bf16 v[24:27], v[40:43], v[72:75], v[24:27]
    v_mfma_f32_16x16x32_bf16 v[24:27], v[44:47], v[76:79], v[24:27]
    v_mfma_f32_16x16x32_bf16 v[24:27], v[48:51], v[80:83], v[24:27]
    v_mfma_f32_16x16x32_bf16 v[24:27], v[52:55], v[84:87], v[24:27]
    v_mfma_f32_16x16x32_bf16 v[24:27], v[56:59], v[88:91], v[24:27]
    s_lshl_b32 s38, s33, 9
    s_add_u32 s38, s38, 57344
    v_add_u32 v8, s38, v3
    s_nop 7
    s_mov_b64 exec, 0xffffffff
    ds_write_b128 v8, v[24:27]
    s_mov_b64 exec, -1
    s_waitcnt lgkmcnt(0)
    s_barrier
    s_cmp_lg_u32 s33, 0
    s_cbranch_scc1 L_k3_fin
    s_mov_b64 exec, 0xffffffff
    v_add_u32 v8, 57344, v3
    ds_read_b128 v[32:35], v8 offset:0
    ds_read_b128 v[36:39], v8 offset:512
    ds_read_b128 v[40:43], v8 offset:1024
    ds_read_b128 v[44:47], v8 offset:1536
    ds_read_b128 v[48:51], v8 offset:2048
    ds_read_b128 v[52:55], v8 offset:2560
    ds_read_b128 v[56:59], v8 offset:3072
    ds_read_b128 v[60:63], v8 offset:3584
    s_waitcnt vmcnt(0) lgkmcnt(0)
    v_add_f32 v32, v32, v36
    v_add_f32 v40, v40, v44
    v_add_f32 v48, v48, v52
    v_add_f32 v56, v56, v60
    v_add_f32 v32, v32, v40
    v_add_f32 v48, v48, v56
    v_add_f32 v32, v32, v48
    v_add_f32 v33, v33, v37
    v_add_f32 v41, v41, v45
    v_add_f32 v49, v49, v53
    v_add_f32 v57, v57, v61
    v_add_f32 v33, v33, v41
    v_add_f32 v49, v49, v57
    v_add_f32 v33, v33, v49
    v_add_f32 v34, v34, v38
    v_add_f32 v42, v42, v46
    v_add_f32 v50, v50, v54
    v_add_f32 v58, v58, v62
    v_add_f32 v34, v34, v42
    v_add_f32 v50, v50, v58
    v_add_f32 v34, v34, v50
    v_add_f32 v35, v35, v39
    v_add_f32 v43, v43, v47
    v_add_f32 v51, v51, v55
    v_add_f32 v59, v59, v63
    v_add_f32 v35, v35, v43
    v_add_f32 v51, v51, v59
    v_add_f32 v35, v35, v51
    v_cvt_pk_bf16_f32 v32, v32, v32
    v_lshlrev_b32 v32, 16, v32
    v_mul_f32 v32, v32, v104
    v_cvt_pk_bf16_f32 v32, v32, v32
    v_lshlrev_b32 v32, 16, v32
    v_add_f32 v100, v100, v32
    v_cvt_pk_bf16_f32 v100, v100, v100
    v_lshlrev_b32 v100, 16, v100
    v_add_f32 v96, v96, v100
    v_cvt_pk_bf16_f32 v96, v96, v96
    buffer_store_short v96, v16, s[24:27], 0 offen sc1
    v_cvt_pk_bf16_f32 v33, v33, v33
    v_lshlrev_b32 v33, 16, v33
    v_mul_f32 v33, v33, v105
    v_cvt_pk_bf16_f32 v33, v33, v33
    v_lshlrev_b32 v33, 16, v33
    v_add_f32 v101, v101, v33
    v_cvt_pk_bf16_f32 v101, v101, v101
    v_lshlrev_b32 v101, 16, v101
    v_add_f32 v97, v97, v101
    v_cvt_pk_bf16_f32 v97, v97, v97
    buffer_store_short v97, v17, s[24:27], 0 offen sc1
    v_cvt_pk_bf16_f32 v34, v34, v34
    v_lshlrev_b32 v34, 16, v34
    v_mul_f32 v34, v34, v106
    v_cvt_pk_bf16_f32 v34, v34, v34
    v_lshlrev_b32 v34, 16, v34
    v_add_f32 v102, v102, v34
    v_cvt_pk_bf16_f32 v102, v102, v102
    v_lshlrev_b32 v102, 16, v102
    v_add_f32 v98, v98, v102
    v_cvt_pk_bf16_f32 v98, v98, v98
    buffer_store_short v98, v18, s[24:27], 0 offen sc1
    v_cvt_pk_bf16_f32 v35, v35, v35
    v_lshlrev_b32 v35, 16, v35
    v_mul_f32 v35, v35, v107
    v_cvt_pk_bf16_f32 v35, v35, v35
    v_lshlrev_b32 v35, 16, v35
    v_add_f32 v103, v103, v35
    v_cvt_pk_bf16_f32 v103, v103, v103
    v_lshlrev_b32 v103, 16, v103
    v_add_f32 v99, v99, v103
    v_cvt_pk_bf16_f32 v99, v99, v99
    buffer_store_short v99, v19, s[24:27], 0 offen sc1
L_k3_fin:
L_k3_end:
    s_endpgm
.section .rodata,"a"
.p2align 6
.amdhsa_kernel k1_lngemm_kernel
  .amdhsa_next_free_vgpr 128
  .amdhsa_next_free_sgpr 96
  .amdhsa_accum_offset 128
  .amdhsa_group_segment_fixed_size 0
  .amdhsa_kernarg_size 104
  .amdhsa_user_sgpr_count 2
  .amdhsa_user_sgpr_kernarg_segment_ptr 1
  .amdhsa_system_sgpr_workgroup_id_x 1
  .amdhsa_float_denorm_mode_32 3
.end_amdhsa_kernel
.p2align 6
.amdhsa_kernel k2_gemm_kernel
  .amdhsa_next_free_vgpr 160
  .amdhsa_next_free_sgpr 96
  .amdhsa_accum_offset 160
  .amdhsa_group_segment_fixed_size 0
  .amdhsa_kernarg_size 104
  .amdhsa_user_sgpr_count 2
  .amdhsa_user_sgpr_kernarg_segment_ptr 1
  .amdhsa_system_sgpr_workgroup_id_x 1
  .amdhsa_float_denorm_mode_32 3
.end_amdhsa_kernel
.p2align 6
.amdhsa_kernel k3_tail_kernel
  .amdhsa_next_free_vgpr 112
  .amdhsa_next_free_sgpr 96
  .amdhsa_accum_offset 112
  .amdhsa_group_segment_fixed_size 0
  .amdhsa_kernarg_size 104
  .amdhsa_user_sgpr_count 2
  .amdhsa_user_sgpr_kernarg_segment_ptr 1
  .amdhsa_system_sgpr_workgroup_id_x 1
  .amdhsa_float_denorm_mode_32 3
.end_amdhsa_kernel
```
